```python
import torch

def _softmax(x, axis=-1):
    return torch.softmax(x, dim=axis)
def _gelu(x):
    return torch.nn.functional.gelu(x, approximate="tanh")
def _silu(x):
    return torch.nn.functional.silu(x)
def _sigmoid(x):
    return torch.sigmoid(x)
def _layernorm(x, axis=-1, eps=1e-5):
    m = x.mean(dim=axis, keepdim=True)
    v = x.var(dim=axis, keepdim=True, unbiased=False)
    return (x - m) / torch.sqrt(v + eps)
def _scatter_add(tgt, idx, src, axis=0):
    return tgt.clone().index_add_(axis, idx, src)
def _segment_sum(src, seg, n):
    out = torch.zeros((n,) + src.shape[1:], dtype=src.dtype)
    return out.index_add_(0, seg, src)
def _pad(x, pw):
    flat = tuple(v for pair in reversed(pw) for v in pair)
    return torch.nn.functional.pad(x, flat)

kernel_name = 'recurrent_scan__ssm_conv_h3__dense_activation_relu__prompt'

def setup_inputs():

    _w = (lambda a: (lambda t: t.to(torch.bfloat16) if t.is_floating_point() else t)(torch.as_tensor(a)))
    def _A_setup():
        B, S, D = 1, 2048, 512
        ks = 4
        return {
            "q": _w((lambda *s: torch.randn(*s, dtype=torch.bfloat16) * 0.05)(B, S, D)),
            "k": _w((lambda *s: torch.randn(*s, dtype=torch.bfloat16) * 0.2)(B, S, D)),
            "v": _w((lambda *s: torch.randn(*s, dtype=torch.bfloat16) * 0.2)(B, S, D)),
            "shift_k": _w((lambda *s: torch.randn(*s, dtype=torch.bfloat16) * 0.2)(D, ks) * 0.5),
            "ssm_k": _w((lambda *s: torch.randn(*s, dtype=torch.bfloat16) * 0.2)(D, S) * (1.0 / S ** 0.5)),
            "ssm_D": _w((lambda *s: torch.randn(*s, dtype=torch.bfloat16) * 0.2)(D)),
        }
    _A_in = _A_setup()

    def _B_setup():
        B, S, D, Dff = 1, 2048, 512, 1376
        return {
            "x": _w((lambda *s: torch.randn(*s, dtype=torch.bfloat16) * 0.05)(B, S, D)),
            "w1": _w((lambda *s: torch.randn(*s, dtype=torch.bfloat16) * 0.1)(D, Dff)),
            "w2": _w((lambda *s: torch.randn(*s, dtype=torch.bfloat16) * 0.1)(Dff, D)),
        }
    _B_in = _B_setup()

    return {
        "A_q": _A_in["q"],
        "A_k": _A_in["k"],
        "A_v": _A_in["v"],
        "A_shift_k": _A_in["shift_k"],
        "A_ssm_k": _A_in["ssm_k"],
        "A_ssm_D": _A_in["ssm_D"],
        "B_x": _B_in["x"],
        "B_w1": _B_in["w1"],
        "B_w2": _B_in["w2"],
    }

def reference(A_q, A_k, A_v, A_shift_k, A_ssm_k, A_ssm_D, B_x, B_w1, B_w2):
    def _A_ref(q, k, v, shift_k, ssm_k, ssm_D):
        B, S, D = q.shape
        ks = shift_k.shape[-1]
        k_pad = _pad(k, ((0, 0), (ks - 1, 0), (0, 0)))
        k_shift = torch.zeros_like(k)
        for t in range(ks):
            k_shift = k_shift + k_pad[:, t:t + S, :] * shift_k[:, ks - 1 - t][None, None, :]
        kv = k_shift * v
        L = 2 * S
        kv_pad = _pad(kv, ((0, 0), (0, S), (0, 0)))
        kf_pad = _pad(ssm_k, ((0, 0), (0, S)))
        kv_f = (lambda x, axes=(-2,-1): torch.fft.rfft2(x.float(), dim=axes))(kv_pad[:, None, :, :], axes=(1, 2))
        kf_f = (lambda x, axes=(-2,-1): torch.fft.rfft2(x.float(), dim=axes))(kf_pad[:, None, :], axes=(1, 2))
        kf_f = (lambda x, *d: x.permute(*d))(kf_f, 1, 2, 0)
        y_f = kv_f * kf_f[None, :, :, :]
        y = (lambda x, s, axes=(-2,-1): torch.fft.irfft2(x, s=s, dim=axes).to(torch.bfloat16))(y_f, (1, L), axes=(1, 2))[:, 0, :S, :]
        y = y + kv * ssm_D[None, None, :]
        return q * y

    def _B_ref(x, w1, w2):
        h = torch.einsum("bsd,df->bsf", x, w1)
        zero = torch.zeros_like(h)
        h = torch.maximum(h, zero)
        return torch.einsum("bsf,fd->bsd", h, w2)

    x = A_q
    xn = _layernorm(x, axis=-1)
    s = _A_ref(xn, A_k, A_v, A_shift_k, A_ssm_k, A_ssm_D)
    g = _silu(_B_ref(xn, B_w1, B_w2))
    return x + s * g
```

```asm
; @launch grid=(256,1,1) block=(512,1,1) lds=163840
.amdgcn_target "amdgcn-amd-amdhsa--gfx950"
.text
.globl recurrent_scan__ssm_conv_h3__dense_activation_relu__prompt_kernel
.p2align 8
.type recurrent_scan__ssm_conv_h3__dense_activation_relu__prompt_kernel,@function
recurrent_scan__ssm_conv_h3__dense_activation_relu__prompt_kernel:
    s_load_dwordx8 s[64:71], s[0:1], 0
    s_cmp_ge_u32 s2, 256
    s_cbranch_scc1 L_end
    v_lshrrev_b32 v2, 6, v0
    v_and_b32 v1, 63, v0
    s_getpc_b64 s[82:83]
L_pc:
    s_sub_u32 s82, s82, L_pc-recurrent_scan__ssm_conv_h3__dense_activation_relu__prompt_kernel
    s_subb_u32 s83, s83, 0
    v_and_b32 v4, 255, v0
    v_lshlrev_b32 v4, 7, v4
    v_min_u32 v4, L_codeend-recurrent_scan__ssm_conv_h3__dense_activation_relu__prompt_kernel, v4
    v_mov_b32 v5, s83
    v_add_co_u32 v4, vcc, s82, v4
    s_nop 1
    v_addc_co_u32 v5, vcc, 0, v5, vcc
    global_load_dword v244, v[4:5], off
    s_and_b32 s48, s2, 3
    s_lshl_b32 s48, s48, 3
    s_bfe_u32 s3, s2, 0x30003
    s_add_u32 s48, s48, s3
    s_bfe_u32 s49, s2, 0x10002
    s_lshl_b32 s49, s49, 2
    s_lshr_b32 s3, s2, 6
    s_add_u32 s49, s49, s3
    v_readfirstlane_b32 s50, v2
    s_mov_b32 s10, 0x200000
    s_mov_b32 s11, 0x00020000
    s_mov_b32 s14, 0x200000
    s_mov_b32 s15, 0x00020000
    s_mov_b32 s18, 0x200000
    s_mov_b32 s19, 0x00020000
    s_movk_i32 s42, 0x1000
    s_mov_b32 s43, 0x00020000
    s_and_b32 s59, s50, 3
    s_cmp_ge_u32 s50, 4
    s_cbranch_scc1 L_Hfirst
    v_lshrrev_b32 v3, 5, v0
    v_and_b32 v4, 31, v0
    s_lshl_b32 s55, s48, 16
    s_lshl_b32 s56, s49, 7
    s_add_u32 s55, s55, s56
    v_lshlrev_b32 v2, 13, v3
    v_lshl_add_u32 v2, v4, 2, v2
    v_add_u32 v2, s55, v2
    v_add_u32 v5, 0xfffff400, v2
    v_add_u32 v6, 0xfffff800, v2
    v_add_u32 v7, 0xfffffc00, v2
    v_add_u32 v8, 4096, v2
    s_lshl_b32 s57, s49, 9
    v_lshlrev_b32 v9, 4, v4
    v_add_u32 v9, s57, v9
    s_waitcnt lgkmcnt(0)
    s_mov_b64 s[12:13], s[66:67]
    s_mov_b64 s[16:17], s[68:69]
    s_mov_b64 s[40:41], s[70:71]
    s_mov_b64 s[8:9], s[64:65]
    buffer_load_dword v20, v5, s[12:15], 0 offen
    buffer_load_dword v21, v6, s[12:15], 0 offen
    buffer_load_dword v22, v7, s[12:15], 0 offen
    buffer_load_dword v23, v2, s[12:15], 0 offen offset:0
    buffer_load_dword v24, v2, s[12:15], 0 offen offset:1024
    buffer_load_dword v25, v2, s[12:15], 0 offen offset:2048
    buffer_load_dword v26, v2, s[12:15], 0 offen offset:3072
    buffer_load_dword v27, v8, s[12:15], 0 offen offset:0
    buffer_load_dword v28, v8, s[12:15], 0 offen offset:1024
    buffer_load_dword v29, v8, s[12:15], 0 offen offset:2048
    buffer_load_dword v30, v8, s[12:15], 0 offen offset:3072
    buffer_load_dwordx4 v[40:43], v9, s[40:43], 0 offen
    buffer_load_dword v32, v2, s[16:19], 0 offen offset:0
    buffer_load_dword v33, v2, s[16:19], 0 offen offset:1024
    buffer_load_dword v34, v2, s[16:19], 0 offen offset:2048
    buffer_load_dword v35, v2, s[16:19], 0 offen offset:3072
    buffer_load_dword v36, v8, s[16:19], 0 offen offset:0
    buffer_load_dword v37, v8, s[16:19], 0 offen offset:1024
    buffer_load_dword v38, v8, s[16:19], 0 offen offset:2048
    buffer_load_dword v39, v8, s[16:19], 0 offen offset:3072
    s_branch L_Mrest
L_Hfirst:
    s_lshl_b32 s55, s48, 16
    s_lshl_b32 s56, s59, 14
    s_add_u32 s55, s55, s56
    v_lshrrev_b32 v6, 2, v1
    v_lshlrev_b32 v6, 10, v6
    v_and_b32 v7, 3, v1
    v_lshl_add_u32 v6, v7, 4, v6
    v_add_u32 v6, s55, v6
    s_waitcnt lgkmcnt(0)
    s_mov_b64 s[8:9], s[64:65]
    buffer_load_dwordx4 v[20:23], v6, s[8:11], 0 offen offset:0
    buffer_load_dwordx4 v[24:27], v6, s[8:11], 0 offen offset:64
    buffer_load_dwordx4 v[28:31], v6, s[8:11], 0 offen offset:128
    buffer_load_dwordx4 v[32:35], v6, s[8:11], 0 offen offset:192
    buffer_load_dwordx4 v[36:39], v6, s[8:11], 0 offen offset:256
    buffer_load_dwordx4 v[40:43], v6, s[8:11], 0 offen offset:320
    buffer_load_dwordx4 v[44:47], v6, s[8:11], 0 offen offset:384
    buffer_load_dwordx4 v[48:51], v6, s[8:11], 0 offen offset:448
    buffer_load_dwordx4 v[52:55], v6, s[8:11], 0 offen offset:512
    buffer_load_dwordx4 v[56:59], v6, s[8:11], 0 offen offset:576
    buffer_load_dwordx4 v[60:63], v6, s[8:11], 0 offen offset:640
    buffer_load_dwordx4 v[64:67], v6, s[8:11], 0 offen offset:704
    buffer_load_dwordx4 v[68:71], v6, s[8:11], 0 offen offset:768
    buffer_load_dwordx4 v[72:75], v6, s[8:11], 0 offen offset:832
    buffer_load_dwordx4 v[76:79], v6, s[8:11], 0 offen offset:896
    buffer_load_dwordx4 v[80:83], v6, s[8:11], 0 offen offset:960
    s_branch L_H
L_Mrest:
    s_load_dwordx2 s[20:21], s[0:1], 56
    s_load_dwordx2 s[32:33], s[0:1], 32
    s_load_dwordx2 s[36:37], s[0:1], 88
    s_load_dwordx2 s[44:45], s[0:1], 80
    s_load_dwordx2 s[24:25], s[0:1], 64
    s_load_dwordx2 s[28:29], s[0:1], 72
    s_load_dwordx2 s[64:65], s[0:1], 40
    s_mov_b32 s22, 0x158000
    s_mov_b32 s23, 0x00020000
    s_mov_b32 s34, 0x200000
    s_mov_b32 s35, 0x00020000
    s_mov_b32 s38, 0x1000000
    s_mov_b32 s39, 0x00020000
    s_mov_b32 s46, 0x100
    s_mov_b32 s47, 0x00020000
    s_mov_b32 s26, 0x158000
    s_mov_b32 s27, 0x00020000
    s_mov_b32 s30, 0x200000
    s_mov_b32 s31, 0x00020000
    s_mov_b32 s85, s49
    s_lshl_b32 s81, s49, 5
    s_add_u32 s81, s81, s48
    s_mul_i32 s53, s49, 6
    s_sub_i32 s55, s49, 3
    s_max_i32 s55, s55, 0
    s_sub_u32 s53, s53, s55
    s_lshl_b32 s52, s53, 5
    s_cmp_lt_u32 s49, 3
    s_cselect_b32 s54, 12, 10
    v_mov_b32 v248, 0xffff
    v_mov_b32 v249, 0xffff0000
    v_mov_b32 v250, 0x3f80
    v_mov_b32 v251, 0x3f800000
    v_mov_b32 v252, 0x3f803f80
    s_mov_b32 s68, 0x05040100
    s_mov_b32 s69, 0x07060302
    v_and_b32 v3, 15, v0
    v_lshlrev_b32 v3, 2, v3
    v_add_u32 v3, 162304, v3
    v_mov_b32 v4, 0
    ds_write_b32 v3, v4
    s_waitcnt lgkmcnt(0)
    s_barrier
    s_or_b32 s56, s2, s50
    s_cmp_lg_u32 s56, 0
    s_cbranch_scc1 L_nononce
    s_memrealtime s[4:5]
    s_waitcnt lgkmcnt(0)
    s_or_b32 s4, s4, 1
    v_mov_b32 v2, s4
    v_mov_b32 v3, 0
    s_mov_b64 exec, 1
    buffer_store_dword v2, v3, s[44:47], 0 offen sc1
    s_mov_b64 exec, -1
L_nononce:
    s_mul_i32 s55, s59, 44032
    s_lshl_b32 s56, s52, 1
    s_add_u32 s55, s55, s56
    s_lshl_b32 s56, s54, 1
    v_mov_b32 v7, 0x40000000
    v_add_u32 v2, 0, v1
    v_mul_u32_u24 v3, 2731, v2
    v_lshrrev_b32 v3, 16, v3
    v_mul_u32_u24 v4, 24, v3
    v_sub_u32 v4, v2, v4
    v_and_b32 v5, 2, v3
    v_lshrrev_b32 v6, 1, v3
    v_and_b32 v6, 4, v6
    v_or_b32 v5, v5, v6
    v_xor_b32 v4, v4, v5
    v_mul_u32_u24 v5, 2752, v3
    v_lshl_add_u32 v5, v4, 4, v5
    v_add_u32 v5, s55, v5
    v_cmp_gt_u32 vcc, s56, v4
    s_nop 1
    v_cndmask_b32 v12, v7, v5, vcc
    v_add_u32 v2, 64, v1
    v_mul_u32_u24 v3, 2731, v2
    v_lshrrev_b32 v3, 16, v3
    v_mul_u32_u24 v4, 24, v3
    v_sub_u32 v4, v2, v4
    v_and_b32 v5, 2, v3
    v_lshrrev_b32 v6, 1, v3
    v_and_b32 v6, 4, v6
    v_or_b32 v5, v5, v6
    v_xor_b32 v4, v4, v5
    v_mul_u32_u24 v5, 2752, v3
    v_lshl_add_u32 v5, v4, 4, v5
    v_add_u32 v5, s55, v5
    v_cmp_gt_u32 vcc, s56, v4
    s_nop 1
    v_cndmask_b32 v13, v7, v5, vcc
    v_add_u32 v2, 128, v1
    v_mul_u32_u24 v3, 2731, v2
    v_lshrrev_b32 v3, 16, v3
    v_mul_u32_u24 v4, 24, v3
    v_sub_u32 v4, v2, v4
    v_and_b32 v5, 2, v3
    v_lshrrev_b32 v6, 1, v3
    v_and_b32 v6, 4, v6
    v_or_b32 v5, v5, v6
    v_xor_b32 v4, v4, v5
    v_mul_u32_u24 v5, 2752, v3
    v_lshl_add_u32 v5, v4, 4, v5
    v_add_u32 v5, s55, v5
    v_cmp_gt_u32 vcc, s56, v4
    s_nop 1
    v_cndmask_b32 v14, v7, v5, vcc
    v_add_u32 v2, 192, v1
    v_mul_u32_u24 v3, 2731, v2
    v_lshrrev_b32 v3, 16, v3
    v_mul_u32_u24 v4, 24, v3
    v_sub_u32 v4, v2, v4
    v_and_b32 v5, 2, v3
    v_lshrrev_b32 v6, 1, v3
    v_and_b32 v6, 4, v6
    v_or_b32 v5, v5, v6
    v_xor_b32 v4, v4, v5
    v_mul_u32_u24 v5, 2752, v3
    v_lshl_add_u32 v5, v4, 4, v5
    v_add_u32 v5, s55, v5
    v_cmp_gt_u32 vcc, s56, v4
    s_nop 1
    v_cndmask_b32 v15, v7, v5, vcc
    v_add_u32 v2, 256, v1
    v_mul_u32_u24 v3, 2731, v2
    v_lshrrev_b32 v3, 16, v3
    v_mul_u32_u24 v4, 24, v3
    v_sub_u32 v4, v2, v4
    v_and_b32 v5, 2, v3
    v_lshrrev_b32 v6, 1, v3
    v_and_b32 v6, 4, v6
    v_or_b32 v5, v5, v6
    v_xor_b32 v4, v4, v5
    v_mul_u32_u24 v5, 2752, v3
    v_lshl_add_u32 v5, v4, 4, v5
    v_add_u32 v5, s55, v5
    v_cmp_gt_u32 vcc, s56, v4
    s_nop 1
    v_cndmask_b32 v16, v7, v5, vcc
    v_add_u32 v2, 320, v1
    v_mul_u32_u24 v3, 2731, v2
    v_lshrrev_b32 v3, 16, v3
    v_mul_u32_u24 v4, 24, v3
    v_sub_u32 v4, v2, v4
    v_and_b32 v5, 2, v3
    v_lshrrev_b32 v6, 1, v3
    v_and_b32 v6, 4, v6
    v_or_b32 v5, v5, v6
    v_xor_b32 v4, v4, v5
    v_mul_u32_u24 v5, 2752, v3
    v_lshl_add_u32 v5, v4, 4, v5
    v_add_u32 v5, s55, v5
    v_cmp_gt_u32 vcc, s56, v4
    s_nop 1
    v_cndmask_b32 v17, v7, v5, vcc
    s_mul_i32 s67, s59, 6144
    s_add_u32 s67, s67, 32768
    v_and_b32 v2, 15, v1
    v_lshrrev_b32 v3, 4, v1
    v_lshlrev_b32 v4, 1, v3
    v_xor_b32 v4, v2, v4
    v_lshlrev_b32 v4, 4, v4
    v_lshl_add_u32 v8, v3, 8, v4
    v_lshrrev_b32 v5, 2, v2
    v_lshl_add_u32 v4, v3, 3, v5
    v_mul_u32_u24 v4, 384, v4
    v_and_b32 v6, 3, v1
    v_lshl_add_u32 v4, v6, 3, v4
    v_lshrrev_b32 v5, 1, v5
    v_and_b32 v6, 1, v3
    v_lshl_add_u32 v5, v6, 1, v5
    s_mul_i32 s55, s59, 3
    s_add_u32 s56, s55, 0
    v_xor_b32 v6, s56, v5
    v_lshl_add_u32 v6, v6, 5, v4
    v_add_u32 v9, 32768, v6
    s_add_u32 s56, s55, 1
    v_xor_b32 v6, s56, v5
    v_lshl_add_u32 v6, v6, 5, v4
    v_add_u32 v10, 32768, v6
    s_add_u32 s56, s55, 2
    v_xor_b32 v6, s56, v5
    v_lshl_add_u32 v6, v6, 5, v4
    v_add_u32 v11, 32768, v6
    v_lshlrev_b32 v5, 4, v2
    v_lshrrev_b32 v4, 1, v3
    v_lshl_add_u32 v5, v4, 8, v5
    v_and_b32 v4, 1, v3
    v_lshl_add_u32 v5, v4, 3, v5
    s_lshr_b32 s53, s52, 4
    s_mul_i32 s55, s48, 176128
    s_mul_i32 s56, s59, 3
    s_add_u32 s57, s56, s53
    s_lshl_b32 s57, s57, 9
    s_add_u32 s55, s55, s57
    s_add_u32 s55, s55, 0x400000
    v_add_u32 v168, s55, v5
    v_add_u32 v169, 44032, v168
    v_add_u32 v170, 88064, v168
    v_add_u32 v171, 132096, v168
    s_add_u32 s57, s56, 1
    s_cmp_lt_u32 s57, s54
    s_cselect_b32 s73, 0, 0x40000000
    s_add_u32 s57, s56, 2
    s_cmp_lt_u32 s57, s54
    s_cselect_b32 s74, 0, 0x40000000
    s_lshl_b32 s55, s49, 7
    s_lshl_b32 s56, s48, 2
    s_add_u32 s55, s55, s56
    s_load_dword s66, s[64:65], s55
    s_mov_b32 s56, 0
    s_add_u32 m0, s67, 0
    s_nop 0
    buffer_load_dwordx4 v12, s[20:23], s56 offen lds
    s_add_u32 m0, s67, 1024
    s_nop 0
    buffer_load_dwordx4 v13, s[20:23], s56 offen lds
    s_add_u32 m0, s67, 2048
    s_nop 0
    buffer_load_dwordx4 v14, s[20:23], s56 offen lds
    s_add_u32 m0, s67, 3072
    s_nop 0
    buffer_load_dwordx4 v15, s[20:23], s56 offen lds
    s_add_u32 m0, s67, 4096
    s_nop 0
    buffer_load_dwordx4 v16, s[20:23], s56 offen lds
    s_add_u32 m0, s67, 5120
    s_nop 0
    buffer_load_dwordx4 v17, s[20:23], s56 offen lds
    s_mov_b32 s56, 176128
    s_add_u32 m0, s67, 24576
    s_nop 0
    buffer_load_dwordx4 v12, s[20:23], s56 offen lds
    s_add_u32 m0, s67, 25600
    s_nop 0
    buffer_load_dwordx4 v13, s[20:23], s56 offen lds
    s_add_u32 m0, s67, 26624
    s_nop 0
    buffer_load_dwordx4 v14, s[20:23], s56 offen lds
    s_add_u32 m0, s67, 27648
    s_nop 0
    buffer_load_dwordx4 v15, s[20:23], s56 offen lds
    s_add_u32 m0, s67, 28672
    s_nop 0
    buffer_load_dwordx4 v16, s[20:23], s56 offen lds
    s_add_u32 m0, s67, 29696
    s_nop 0
    buffer_load_dwordx4 v17, s[20:23], s56 offen lds
    s_waitcnt vmcnt(12)
    v_and_b32 v44, v248, v40
    v_lshrrev_b32 v45, 16, v40
    v_and_b32 v46, v248, v41
    v_lshrrev_b32 v47, 16, v41
    v_lshlrev_b32 v48, 16, v42
    v_and_b32 v49, v249, v42
    v_lshlrev_b32 v50, 16, v43
    v_and_b32 v51, v249, v43
    v_dot2_f32_bf16 v52, v20, v47, 0
    v_dot2_f32_bf16 v56, v20, v51, 0
    v_dot2_f32_bf16 v53, v21, v47, 0
    v_dot2_f32_bf16 v57, v21, v51, 0
    v_dot2_f32_bf16 v54, v22, v47, 0
    v_dot2_f32_bf16 v58, v22, v51, 0
    v_dot2_f32_bf16 v55, v23, v47, 0
    v_dot2_f32_bf16 v59, v23, v51, 0
    v_cvt_pk_bf16_f32 v64, v52, v56
    v_cvt_pk_bf16_f32 v65, v53, v57
    v_cvt_pk_bf16_f32 v66, v54, v58
    v_cvt_pk_bf16_f32 v67, v55, v59
    v_dot2_f32_bf16 v52, v21, v46, 0
    v_dot2_f32_bf16 v56, v21, v50, 0
    v_dot2_f32_bf16 v53, v22, v46, 0
    v_dot2_f32_bf16 v57, v22, v50, 0
    v_dot2_f32_bf16 v54, v23, v46, 0
    v_dot2_f32_bf16 v58, v23, v50, 0
    v_dot2_f32_bf16 v55, v24, v46, 0
    v_dot2_f32_bf16 v59, v24, v50, 0
    v_cvt_pk_bf16_f32 v60, v52, v56
    v_cvt_pk_bf16_f32 v61, v53, v57
    v_cvt_pk_bf16_f32 v62, v54, v58
    v_cvt_pk_bf16_f32 v63, v55, v59
    v_perm_b32 v68, v60, v64, s68
    v_perm_b32 v72, v60, v64, s69
    v_perm_b32 v69, v61, v65, s68
    v_perm_b32 v73, v61, v65, s69
    v_perm_b32 v70, v62, v66, s68
    v_perm_b32 v74, v62, v66, s69
    v_perm_b32 v71, v63, v67, s68
    v_perm_b32 v75, v63, v67, s69
    v_dot2_f32_bf16 v52, v68, v252, 0
    v_dot2_f32_bf16 v56, v72, v252, 0
    v_dot2_f32_bf16 v53, v69, v252, 0
    v_dot2_f32_bf16 v57, v73, v252, 0
    v_dot2_f32_bf16 v54, v70, v252, 0
    v_dot2_f32_bf16 v58, v74, v252, 0
    v_dot2_f32_bf16 v55, v71, v252, 0
    v_dot2_f32_bf16 v59, v75, v252, 0
    v_cvt_pk_bf16_f32 v64, v52, v56
    v_cvt_pk_bf16_f32 v65, v53, v57
    v_cvt_pk_bf16_f32 v66, v54, v58
    v_cvt_pk_bf16_f32 v67, v55, v59
    v_dot2_f32_bf16 v52, v22, v45, 0
    v_dot2_f32_bf16 v56, v22, v49, 0
    v_dot2_f32_bf16 v53, v23, v45, 0
    v_dot2_f32_bf16 v57, v23, v49, 0
    v_dot2_f32_bf16 v54, v24, v45, 0
    v_dot2_f32_bf16 v58, v24, v49, 0
    v_dot2_f32_bf16 v55, v25, v45, 0
    v_dot2_f32_bf16 v59, v25, v49, 0
    v_cvt_pk_bf16_f32 v60, v52, v56
    v_cvt_pk_bf16_f32 v61, v53, v57
    v_cvt_pk_bf16_f32 v62, v54, v58
    v_cvt_pk_bf16_f32 v63, v55, v59
    v_perm_b32 v68, v60, v64, s68
    v_perm_b32 v72, v60, v64, s69
    v_perm_b32 v69, v61, v65, s68
    v_perm_b32 v73, v61, v65, s69
    v_perm_b32 v70, v62, v66, s68
    v_perm_b32 v74, v62, v66, s69
    v_perm_b32 v71, v63, v67, s68
    v_perm_b32 v75, v63, v67, s69
    v_dot2_f32_bf16 v52, v68, v252, 0
    v_dot2_f32_bf16 v56, v72, v252, 0
    v_dot2_f32_bf16 v53, v69, v252, 0
    v_dot2_f32_bf16 v57, v73, v252, 0
    v_dot2_f32_bf16 v54, v70, v252, 0
    v_dot2_f32_bf16 v58, v74, v252, 0
    v_dot2_f32_bf16 v55, v71, v252, 0
    v_dot2_f32_bf16 v59, v75, v252, 0
    v_cvt_pk_bf16_f32 v64, v52, v56
    v_cvt_pk_bf16_f32 v65, v53, v57
    v_cvt_pk_bf16_f32 v66, v54, v58
    v_cvt_pk_bf16_f32 v67, v55, v59
    v_dot2_f32_bf16 v52, v23, v44, 0
    v_dot2_f32_bf16 v56, v23, v48, 0
    v_dot2_f32_bf16 v53, v24, v44, 0
    v_dot2_f32_bf16 v57, v24, v48, 0
    v_dot2_f32_bf16 v54, v25, v44, 0
    v_dot2_f32_bf16 v58, v25, v48, 0
    v_dot2_f32_bf16 v55, v26, v44, 0
    v_dot2_f32_bf16 v59, v26, v48, 0
    v_cvt_pk_bf16_f32 v60, v52, v56
    v_cvt_pk_bf16_f32 v61, v53, v57
    v_cvt_pk_bf16_f32 v62, v54, v58
    v_cvt_pk_bf16_f32 v63, v55, v59
    v_perm_b32 v68, v60, v64, s68
    v_perm_b32 v72, v60, v64, s69
    v_perm_b32 v69, v61, v65, s68
    v_perm_b32 v73, v61, v65, s69
    v_perm_b32 v70, v62, v66, s68
    v_perm_b32 v74, v62, v66, s69
    v_perm_b32 v71, v63, v67, s68
    v_perm_b32 v75, v63, v67, s69
    v_dot2_f32_bf16 v52, v68, v252, 0
    v_dot2_f32_bf16 v56, v72, v252, 0
    v_dot2_f32_bf16 v53, v69, v252, 0
    v_dot2_f32_bf16 v57, v73, v252, 0
    v_dot2_f32_bf16 v54, v70, v252, 0
    v_dot2_f32_bf16 v58, v74, v252, 0
    v_dot2_f32_bf16 v55, v71, v252, 0
    v_dot2_f32_bf16 v59, v75, v252, 0
    v_cvt_pk_bf16_f32 v64, v52, v56
    v_cvt_pk_bf16_f32 v65, v53, v57
    v_cvt_pk_bf16_f32 v66, v54, v58
    v_cvt_pk_bf16_f32 v67, v55, v59
    v_and_b32 v68, v248, v32
    v_and_b32 v72, v249, v32
    v_and_b32 v69, v248, v33
    v_and_b32 v73, v249, v33
    v_and_b32 v70, v248, v34
    v_and_b32 v74, v249, v34
    v_and_b32 v71, v248, v35
    v_and_b32 v75, v249, v35
    v_dot2_f32_bf16 v76, v64, v68, 0
    v_dot2_f32_bf16 v84, v64, v72, 0
    v_dot2_f32_bf16 v77, v65, v69, 0
    v_dot2_f32_bf16 v85, v65, v73, 0
    v_dot2_f32_bf16 v78, v66, v70, 0
    v_dot2_f32_bf16 v86, v66, v74, 0
    v_dot2_f32_bf16 v79, v67, v71, 0
    v_dot2_f32_bf16 v87, v67, v75, 0
    v_dot2_f32_bf16 v52, v24, v47, 0
    v_dot2_f32_bf16 v56, v24, v51, 0
    v_dot2_f32_bf16 v53, v25, v47, 0
    v_dot2_f32_bf16 v57, v25, v51, 0
    v_dot2_f32_bf16 v54, v26, v47, 0
    v_dot2_f32_bf16 v58, v26, v51, 0
    v_dot2_f32_bf16 v55, v27, v47, 0
    v_dot2_f32_bf16 v59, v27, v51, 0
    v_cvt_pk_bf16_f32 v64, v52, v56
    v_cvt_pk_bf16_f32 v65, v53, v57
    v_cvt_pk_bf16_f32 v66, v54, v58
    v_cvt_pk_bf16_f32 v67, v55, v59
    v_dot2_f32_bf16 v52, v25, v46, 0
    v_dot2_f32_bf16 v56, v25, v50, 0
    v_dot2_f32_bf16 v53, v26, v46, 0
    v_dot2_f32_bf16 v57, v26, v50, 0
    v_dot2_f32_bf16 v54, v27, v46, 0
    v_dot2_f32_bf16 v58, v27, v50, 0
    v_dot2_f32_bf16 v55, v28, v46, 0
    v_dot2_f32_bf16 v59, v28, v50, 0
    v_cvt_pk_bf16_f32 v60, v52, v56
    v_cvt_pk_bf16_f32 v61, v53, v57
    v_cvt_pk_bf16_f32 v62, v54, v58
    v_cvt_pk_bf16_f32 v63, v55, v59
    v_perm_b32 v68, v60, v64, s68
    v_perm_b32 v72, v60, v64, s69
    v_perm_b32 v69, v61, v65, s68
    v_perm_b32 v73, v61, v65, s69
    v_perm_b32 v70, v62, v66, s68
    v_perm_b32 v74, v62, v66, s69
    v_perm_b32 v71, v63, v67, s68
    v_perm_b32 v75, v63, v67, s69
    v_dot2_f32_bf16 v52, v68, v252, 0
    v_dot2_f32_bf16 v56, v72, v252, 0
    v_dot2_f32_bf16 v53, v69, v252, 0
    v_dot2_f32_bf16 v57, v73, v252, 0
    v_dot2_f32_bf16 v54, v70, v252, 0
    v_dot2_f32_bf16 v58, v74, v252, 0
    v_dot2_f32_bf16 v55, v71, v252, 0
    v_dot2_f32_bf16 v59, v75, v252, 0
    v_cvt_pk_bf16_f32 v64, v52, v56
    v_cvt_pk_bf16_f32 v65, v53, v57
    v_cvt_pk_bf16_f32 v66, v54, v58
    v_cvt_pk_bf16_f32 v67, v55, v59
    v_dot2_f32_bf16 v52, v26, v45, 0
    v_dot2_f32_bf16 v56, v26, v49, 0
    v_dot2_f32_bf16 v53, v27, v45, 0
    v_dot2_f32_bf16 v57, v27, v49, 0
    v_dot2_f32_bf16 v54, v28, v45, 0
    v_dot2_f32_bf16 v58, v28, v49, 0
    v_dot2_f32_bf16 v55, v29, v45, 0
    v_dot2_f32_bf16 v59, v29, v49, 0
    v_cvt_pk_bf16_f32 v60, v52, v56
    v_cvt_pk_bf16_f32 v61, v53, v57
    v_cvt_pk_bf16_f32 v62, v54, v58
    v_cvt_pk_bf16_f32 v63, v55, v59
    v_perm_b32 v68, v60, v64, s68
    v_perm_b32 v72, v60, v64, s69
    v_perm_b32 v69, v61, v65, s68
    v_perm_b32 v73, v61, v65, s69
    v_perm_b32 v70, v62, v66, s68
    v_perm_b32 v74, v62, v66, s69
    v_perm_b32 v71, v63, v67, s68
    v_perm_b32 v75, v63, v67, s69
    v_dot2_f32_bf16 v52, v68, v252, 0
    v_dot2_f32_bf16 v56, v72, v252, 0
    v_dot2_f32_bf16 v53, v69, v252, 0
    v_dot2_f32_bf16 v57, v73, v252, 0
    v_dot2_f32_bf16 v54, v70, v252, 0
    v_dot2_f32_bf16 v58, v74, v252, 0
    v_dot2_f32_bf16 v55, v71, v252, 0
    v_dot2_f32_bf16 v59, v75, v252, 0
    v_cvt_pk_bf16_f32 v64, v52, v56
    v_cvt_pk_bf16_f32 v65, v53, v57
    v_cvt_pk_bf16_f32 v66, v54, v58
    v_cvt_pk_bf16_f32 v67, v55, v59
    v_dot2_f32_bf16 v52, v27, v44, 0
    v_dot2_f32_bf16 v56, v27, v48, 0
    v_dot2_f32_bf16 v53, v28, v44, 0
    v_dot2_f32_bf16 v57, v28, v48, 0
    v_dot2_f32_bf16 v54, v29, v44, 0
    v_dot2_f32_bf16 v58, v29, v48, 0
    v_dot2_f32_bf16 v55, v30, v44, 0
    v_dot2_f32_bf16 v59, v30, v48, 0
    v_cvt_pk_bf16_f32 v60, v52, v56
    v_cvt_pk_bf16_f32 v61, v53, v57
    v_cvt_pk_bf16_f32 v62, v54, v58
    v_cvt_pk_bf16_f32 v63, v55, v59
    v_perm_b32 v68, v60, v64, s68
    v_perm_b32 v72, v60, v64, s69
    v_perm_b32 v69, v61, v65, s68
    v_perm_b32 v73, v61, v65, s69
    v_perm_b32 v70, v62, v66, s68
    v_perm_b32 v74, v62, v66, s69
    v_perm_b32 v71, v63, v67, s68
    v_perm_b32 v75, v63, v67, s69
    v_dot2_f32_bf16 v52, v68, v252, 0
    v_dot2_f32_bf16 v56, v72, v252, 0
    v_dot2_f32_bf16 v53, v69, v252, 0
    v_dot2_f32_bf16 v57, v73, v252, 0
    v_dot2_f32_bf16 v54, v70, v252, 0
    v_dot2_f32_bf16 v58, v74, v252, 0
    v_dot2_f32_bf16 v55, v71, v252, 0
    v_dot2_f32_bf16 v59, v75, v252, 0
    v_cvt_pk_bf16_f32 v64, v52, v56
    v_cvt_pk_bf16_f32 v65, v53, v57
    v_cvt_pk_bf16_f32 v66, v54, v58
    v_cvt_pk_bf16_f32 v67, v55, v59
    v_and_b32 v68, v248, v36
    v_and_b32 v72, v249, v36
    v_and_b32 v69, v248, v37
    v_and_b32 v73, v249, v37
    v_and_b32 v70, v248, v38
    v_and_b32 v74, v249, v38
    v_and_b32 v71, v248, v39
    v_and_b32 v75, v249, v39
    v_dot2_f32_bf16 v80, v64, v68, 0
    v_dot2_f32_bf16 v88, v64, v72, 0
    v_dot2_f32_bf16 v81, v65, v69, 0
    v_dot2_f32_bf16 v89, v65, v73, 0
    v_dot2_f32_bf16 v82, v66, v70, 0
    v_dot2_f32_bf16 v90, v66, v74, 0
    v_dot2_f32_bf16 v83, v67, v71, 0
    v_dot2_f32_bf16 v91, v67, v75, 0
    v_and_b32 v2, 31, v0
    v_mul_u32_u24 v2, 288, v2
    v_lshrrev_b32 v3, 5, v0
    v_lshlrev_b32 v3, 4, v3
    v_sub_u32 v2, v2, v3
    v_add_u32 v2, 131184, v2
    v_cvt_pk_bf16_f32 v92, v83, v82
    v_cvt_pk_bf16_f32 v93, v81, v80
    v_cvt_pk_bf16_f32 v94, v79, v78
    v_cvt_pk_bf16_f32 v95, v77, v76
    v_cvt_pk_bf16_f32 v96, v91, v90
    v_cvt_pk_bf16_f32 v97, v89, v88
    v_cvt_pk_bf16_f32 v98, v87, v86
    v_cvt_pk_bf16_f32 v99, v85, v84
    ds_write_b128 v2, v[92:95]
    ds_write_b128 v2, v[96:99] offset:144
    v_lshrrev_b32 v2, 3, v0
    v_and_b32 v3, 7, v0
    v_mul_u32_u24 v4, 144, v2
    v_lshl_add_u32 v4, v3, 4, v4
    v_add_u32 v4, 131072, v4
    s_lshl_b32 s55, s49, 18
    s_lshl_b32 s56, s48, 7
    s_sub_u32 s55, s55, s56
    s_add_u32 s55, s55, 3968
    v_lshlrev_b32 v5, 12, v2
    v_lshl_add_u32 v5, v3, 4, v5
    v_add_u32 v5, s55, v5
    v_add_u32 v6, 131072, v5
    v_mov_b32 v2, 162356
    v_mov_b32 v3, 1
    s_waitcnt lgkmcnt(0)
    s_mov_b64 exec, 1
    ds_add_u32 v2, v3
    s_mov_b64 exec, -1
    s_mov_b32 s5, 162356
    v_mov_b32 v2, s5
    s_mov_b32 s58, 0
L_ps_1:
    ds_read_b32 v3, v2
    s_waitcnt lgkmcnt(0)
    v_readfirstlane_b32 s4, v3
    s_add_u32 s58, s58, 1
    s_cmp_ge_u32 s4, 4
    s_cbranch_scc1 L_psd_2
    s_cmp_lt_u32 s58, 1000000
    s_cbranch_scc1 L_ps_1
L_psd_2:
    ds_read_b128 v[92:95], v4
    ds_read_b128 v[96:99], v4 offset:4608
    s_waitcnt lgkmcnt(0)
    buffer_store_dwordx4 v[92:95], v5, s[36:39], 0 offen sc1
    buffer_store_dwordx4 v[96:99], v6, s[36:39], 0 offen sc1
    v_mov_b32 v7, 0
    buffer_load_dword v19, v7, s[44:47], 0 offen sc1
    s_mov_b32 s56, 352256
    s_add_u32 m0, s67, 49152
    s_nop 0
    buffer_load_dwordx4 v12, s[20:23], s56 offen lds
    s_add_u32 m0, s67, 50176
    s_nop 0
    buffer_load_dwordx4 v13, s[20:23], s56 offen lds
    s_add_u32 m0, s67, 51200
    s_nop 0
    buffer_load_dwordx4 v14, s[20:23], s56 offen lds
    s_add_u32 m0, s67, 52224
    s_nop 0
    buffer_load_dwordx4 v15, s[20:23], s56 offen lds
    s_add_u32 m0, s67, 53248
    s_nop 0
    buffer_load_dwordx4 v16, s[20:23], s56 offen lds
    s_add_u32 m0, s67, 54272
    s_nop 0
    buffer_load_dwordx4 v17, s[20:23], s56 offen lds
    v_mov_b32 v20, 0
    v_mov_b32 v21, 0
    v_mov_b32 v22, 0
    v_mov_b32 v23, 0
    v_mov_b32 v24, 0
    v_mov_b32 v25, 0
    v_mov_b32 v26, 0
    v_mov_b32 v27, 0
    v_mov_b32 v28, 0
    v_mov_b32 v29, 0
    v_mov_b32 v30, 0
    v_mov_b32 v31, 0
    v_mov_b32 v32, 0
    v_mov_b32 v33, 0
    v_mov_b32 v34, 0
    v_mov_b32 v35, 0
    v_mov_b32 v36, 0
    v_mov_b32 v37, 0
    v_mov_b32 v38, 0
    v_mov_b32 v39, 0
    v_mov_b32 v40, 0
    v_mov_b32 v41, 0
    v_mov_b32 v42, 0
    v_mov_b32 v43, 0
    v_mov_b32 v44, 0
    v_mov_b32 v45, 0
    v_mov_b32 v46, 0
    v_mov_b32 v47, 0
    v_mov_b32 v48, 0
    v_mov_b32 v49, 0
    v_mov_b32 v50, 0
    v_mov_b32 v51, 0
    v_mov_b32 v52, 0
    v_mov_b32 v53, 0
    v_mov_b32 v54, 0
    v_mov_b32 v55, 0
    v_mov_b32 v56, 0
    v_mov_b32 v57, 0
    v_mov_b32 v58, 0
    v_mov_b32 v59, 0
    v_mov_b32 v60, 0
    v_mov_b32 v61, 0
    v_mov_b32 v62, 0
    v_mov_b32 v63, 0
    v_mov_b32 v64, 0
    v_mov_b32 v65, 0
    v_mov_b32 v66, 0
    v_mov_b32 v67, 0
    s_waitcnt vmcnt(9)
    s_barrier
    ds_read_b64_tr_b16 v[84:85], v9 offset:0
    ds_read_b64_tr_b16 v[86:87], v9 offset:1536
    ds_read_b128 v[68:71], v8 offset:0
    ds_read_b128 v[72:75], v8 offset:2048
    ds_read_b128 v[76:79], v8 offset:4096
    ds_read_b128 v[80:83], v8 offset:6144
    ds_read_b64_tr_b16 v[88:89], v10 offset:0
    ds_read_b64_tr_b16 v[90:91], v10 offset:1536
    ds_read_b64_tr_b16 v[92:93], v11 offset:0
    ds_read_b64_tr_b16 v[94:95], v11 offset:1536
    s_waitcnt vmcnt(6)
    v_readfirstlane_b32 s51, v19
    s_nop 3
    s_cmp_lg_u32 s51, 0
    s_cbranch_scc1 L_nz_3
    s_mov_b32 s58, 0
L_nl_4:
    v_mov_b32 v7, 0
    buffer_load_dword v19, v7, s[44:47], 0 offen sc1
    s_waitcnt vmcnt(0)
    v_readfirstlane_b32 s51, v19
    s_add_u32 s58, s58, 1
    s_cmp_gt_u32 s58, 100000
    s_cbranch_scc1 L_nz_3
    s_cmp_eq_u32 s51, 0
    s_cbranch_scc1 L_nl_4
L_nz_3:
    s_waitcnt vmcnt(7)
    s_lshl_b32 s55, s81, 7
    s_lshl_b32 s57, s59, 2
    s_add_u32 s55, s55, s57
    s_add_u32 s55, s55, 0xa00000
    v_mov_b32 v2, s55
    v_mov_b32 v3, s51
    s_mov_b64 exec, 1
    buffer_store_dword v3, v2, s[36:39], 0 offen sc1
    s_mov_b64 exec, -1
    ds_read_b64_tr_b16 v[112:113], v9 offset:12288
    ds_read_b64_tr_b16 v[114:115], v9 offset:13824
    ds_read_b128 v[96:99], v8 offset:1024
    ds_read_b128 v[100:103], v8 offset:3072
    ds_read_b128 v[104:107], v8 offset:5120
    s_waitcnt lgkmcnt(5)
    v_mfma_f32_16x16x32_bf16 v[20:23], v[84:87], v[68:71], v[20:23]
    ds_read_b128 v[108:111], v8 offset:7168
    ds_read_b64_tr_b16 v[116:117], v10 offset:12288
    v_mfma_f32_16x16x32_bf16 v[24:27], v[84:87], v[72:75], v[24:27]
    s_mov_b32 s56, 528384
    s_add_u32 m0, s67, 73728
    s_nop 0
    buffer_load_dwordx4 v12, s[20:23], s56 offen lds
    ds_read_b64_tr_b16 v[118:119], v10 offset:13824
    v_mfma_f32_16x16x32_bf16 v[28:31], v[84:87], v[76:79], v[28:31]
    ds_read_b64_tr_b16 v[120:121], v11 offset:12288
    ds_read_b64_tr_b16 v[122:123], v11 offset:13824
    v_mfma_f32_16x16x32_bf16 v[32:35], v[84:87], v[80:83], v[32:35]
    s_add_u32 m0, s67, 74752
    s_nop 0
    buffer_load_dwordx4 v13, s[20:23], s56 offen lds
    v_add_u32 v9, 24576, v9
    v_mfma_f32_16x16x32_bf16 v[36:39], v[88:91], v[68:71], v[36:39]
    v_add_u32 v10, 24576, v10
    v_add_u32 v11, 24576, v11
    v_mfma_f32_16x16x32_bf16 v[40:43], v[88:91], v[72:75], v[40:43]
    s_add_u32 m0, s67, 75776
    s_nop 0
    buffer_load_dwordx4 v14, s[20:23], s56 offen lds
    ds_read_b64_tr_b16 v[140:141], v9 offset:0
    v_mfma_f32_16x16x32_bf16 v[44:47], v[88:91], v[76:79], v[44:47]
    ds_read_b64_tr_b16 v[142:143], v9 offset:1536
    ds_read_b128 v[124:127], v8 offset:8192
    v_mfma_f32_16x16x32_bf16 v[48:51], v[88:91], v[80:83], v[48:51]
    s_add_u32 m0, s67, 76800
    s_nop 0
    buffer_load_dwordx4 v15, s[20:23], s56 offen lds
    ds_read_b128 v[128:131], v8 offset:10240
    v_mfma_f32_16x16x32_bf16 v[52:55], v[92:95], v[68:71], v[52:55]
    ds_read_b128 v[132:135], v8 offset:12288
    ds_read_b128 v[136:139], v8 offset:14336
    v_mfma_f32_16x16x32_bf16 v[56:59], v[92:95], v[72:75], v[56:59]
    s_add_u32 m0, s67, 77824
    s_nop 0
    buffer_load_dwordx4 v16, s[20:23], s56 offen lds
    ds_read_b64_tr_b16 v[144:145], v10 offset:0
    v_mfma_f32_16x16x32_bf16 v[60:63], v[92:95], v[76:79], v[60:63]
    ds_read_b64_tr_b16 v[146:147], v10 offset:1536
    ds_read_b64_tr_b16 v[148:149], v11 offset:0
    v_mfma_f32_16x16x32_bf16 v[64:67], v[92:95], v[80:83], v[64:67]
    s_add_u32 m0, s67, 78848
    s_nop 0
    buffer_load_dwordx4 v17, s[20:23], s56 offen lds
    ds_read_b64_tr_b16 v[150:151], v11 offset:1536
    s_waitcnt lgkmcnt(10)
    v_mfma_f32_16x16x32_bf16 v[20:23], v[112:115], v[96:99], v[20:23]
    ds_read_b64_tr_b16 v[84:85], v9 offset:12288
    v_mfma_f32_16x16x32_bf16 v[24:27], v[112:115], v[100:103], v[24:27]
    s_mov_b32 s56, 704512
    s_add_u32 m0, s67, 98304
    s_nop 0
    buffer_load_dwordx4 v12, s[20:23], s56 offen lds
    v_mfma_f32_16x16x32_bf16 v[28:31], v[112:115], v[104:107], v[28:31]
    ds_read_b64_tr_b16 v[86:87], v9 offset:13824
    ds_read_b128 v[68:71], v8 offset:9216
    v_mfma_f32_16x16x32_bf16 v[32:35], v[112:115], v[108:111], v[32:35]
    s_add_u32 m0, s67, 99328
    s_nop 0
    buffer_load_dwordx4 v13, s[20:23], s56 offen lds
    v_mfma_f32_16x16x32_bf16 v[36:39], v[116:119], v[96:99], v[36:39]
    ds_read_b128 v[72:75], v8 offset:11264
    v_mfma_f32_16x16x32_bf16 v[40:43], v[116:119], v[100:103], v[40:43]
    s_add_u32 m0, s67, 100352
    s_nop 0
    buffer_load_dwordx4 v14, s[20:23], s56 offen lds
    ds_read_b128 v[76:79], v8 offset:13312
    v_mfma_f32_16x16x32_bf16 v[44:47], v[116:119], v[104:107], v[44:47]
    ds_read_b128 v[80:83], v8 offset:15360
    v_mfma_f32_16x16x32_bf16 v[48:51], v[116:119], v[108:111], v[48:51]
    s_add_u32 m0, s67, 101376
    s_nop 0
    buffer_load_dwordx4 v15, s[20:23], s56 offen lds
    v_mfma_f32_16x16x32_bf16 v[52:55], v[120:123], v[96:99], v[52:55]
    ds_read_b64_tr_b16 v[88:89], v10 offset:12288
    ds_read_b64_tr_b16 v[90:91], v10 offset:13824
    v_mfma_f32_16x16x32_bf16 v[56:59], v[120:123], v[100:103], v[56:59]
    s_add_u32 m0, s67, 102400
    s_nop 0
    buffer_load_dwordx4 v16, s[20:23], s56 offen lds
    v_mfma_f32_16x16x32_bf16 v[60:63], v[120:123], v[104:107], v[60:63]
    ds_read_b64_tr_b16 v[92:93], v11 offset:12288
    v_mfma_f32_16x16x32_bf16 v[64:67], v[120:123], v[108:111], v[64:67]
    s_add_u32 m0, s67, 103424
    s_nop 0
    buffer_load_dwordx4 v17, s[20:23], s56 offen lds
    ds_read_b64_tr_b16 v[94:95], v11 offset:13824
    s_waitcnt vmcnt(13)
    s_barrier
    s_waitcnt lgkmcnt(10)
    v_mfma_f32_16x16x32_bf16 v[20:23], v[140:143], v[124:127], v[20:23]
    v_add_u32 v9, 24576, v9
    v_mfma_f32_16x16x32_bf16 v[24:27], v[140:143], v[128:131], v[24:27]
    v_add_u32 v10, 24576, v10
    v_mfma_f32_16x16x32_bf16 v[28:31], v[140:143], v[132:135], v[28:31]
    s_mov_b32 s56, 880640
    s_add_u32 m0, s67, 0
    s_nop 0
    buffer_load_dwordx4 v12, s[20:23], s56 offen lds
    v_add_u32 v11, 24576, v11
    v_mfma_f32_16x16x32_bf16 v[32:35], v[140:143], v[136:139], v[32:35]
    ds_read_b64_tr_b16 v[112:113], v9 offset:0
    v_mfma_f32_16x16x32_bf16 v[36:39], v[144:147], v[124:127], v[36:39]
    ds_read_b64_tr_b16 v[114:115], v9 offset:1536
    v_mfma_f32_16x16x32_bf16 v[40:43], v[144:147], v[128:131], v[40:43]
    ds_read_b128 v[96:99], v8 offset:16384
    ds_read_b128 v[100:103], v8 offset:18432
    v_mfma_f32_16x16x32_bf16 v[44:47], v[144:147], v[132:135], v[44:47]
    s_add_u32 m0, s67, 1024
    s_nop 0
    buffer_load_dwordx4 v13, s[20:23], s56 offen lds
    v_mfma_f32_16x16x32_bf16 v[48:51], v[144:147], v[136:139], v[48:51]
    ds_read_b128 v[104:107], v8 offset:20480
    v_mfma_f32_16x16x32_bf16 v[52:55], v[148:151], v[124:127], v[52:55]
    ds_read_b128 v[108:111], v8 offset:22528
    ds_read_b64_tr_b16 v[116:117], v10 offset:0
    v_mfma_f32_16x16x32_bf16 v[56:59], v[148:151], v[128:131], v[56:59]
    ds_read_b64_tr_b16 v[118:119], v10 offset:1536
    v_mfma_f32_16x16x32_bf16 v[60:63], v[148:151], v[132:135], v[60:63]
    s_add_u32 m0, s67, 2048
    s_nop 0
    buffer_load_dwordx4 v14, s[20:23], s56 offen lds
    v_mfma_f32_16x16x32_bf16 v[64:67], v[148:151], v[136:139], v[64:67]
    ds_read_b64_tr_b16 v[120:121], v11 offset:0
    ds_read_b64_tr_b16 v[122:123], v11 offset:1536
    s_waitcnt lgkmcnt(10)
    v_mfma_f32_16x16x32_bf16 v[20:23], v[84:87], v[68:71], v[20:23]
    ds_read_b64_tr_b16 v[140:141], v9 offset:12288
    v_mfma_f32_16x16x32_bf16 v[24:27], v[84:87], v[72:75], v[24:27]
    ds_read_b64_tr_b16 v[142:143], v9 offset:13824
    v_mfma_f32_16x16x32_bf16 v[28:31], v[84:87], v[76:79], v[28:31]
    s_add_u32 m0, s67, 3072
    s_nop 0
    buffer_load_dwordx4 v15, s[20:23], s56 offen lds
    v_mfma_f32_16x16x32_bf16 v[32:35], v[84:87], v[80:83], v[32:35]
    ds_read_b128 v[124:127], v8 offset:17408
    v_mfma_f32_16x16x32_bf16 v[36:39], v[88:91], v[68:71], v[36:39]
    ds_read_b128 v[128:131], v8 offset:19456
    v_mfma_f32_16x16x32_bf16 v[40:43], v[88:91], v[72:75], v[40:43]
    ds_read_b128 v[132:135], v8 offset:21504
    v_mfma_f32_16x16x32_bf16 v[44:47], v[88:91], v[76:79], v[44:47]
    s_add_u32 m0, s67, 4096
    s_nop 0
    buffer_load_dwordx4 v16, s[20:23], s56 offen lds
    v_mfma_f32_16x16x32_bf16 v[48:51], v[88:91], v[80:83], v[48:51]
    ds_read_b128 v[136:139], v8 offset:23552
    v_mfma_f32_16x16x32_bf16 v[52:55], v[92:95], v[68:71], v[52:55]
    ds_read_b64_tr_b16 v[144:145], v10 offset:12288
    v_mfma_f32_16x16x32_bf16 v[56:59], v[92:95], v[72:75], v[56:59]
    ds_read_b64_tr_b16 v[146:147], v10 offset:13824
    v_mfma_f32_16x16x32_bf16 v[60:63], v[92:95], v[76:79], v[60:63]
    s_add_u32 m0, s67, 5120
    s_nop 0
    buffer_load_dwordx4 v17, s[20:23], s56 offen lds
    v_mfma_f32_16x16x32_bf16 v[64:67], v[92:95], v[80:83], v[64:67]
    ds_read_b64_tr_b16 v[148:149], v11 offset:12288
    ds_read_b64_tr_b16 v[150:151], v11 offset:13824
    s_waitcnt vmcnt(12)
    s_barrier
    s_waitcnt lgkmcnt(10)
    v_mfma_f32_16x16x32_bf16 v[20:23], v[112:115], v[96:99], v[20:23]
    v_add_u32 v9, 24576, v9
    v_mfma_f32_16x16x32_bf16 v[24:27], v[112:115], v[100:103], v[24:27]
    v_add_u32 v10, 24576, v10
    v_mfma_f32_16x16x32_bf16 v[28:31], v[112:115], v[104:107], v[28:31]
    s_mov_b32 s56, 1056768
    s_add_u32 m0, s67, 24576
    s_nop 0
    buffer_load_dwordx4 v12, s[20:23], s56 offen lds
    v_add_u32 v11, 24576, v11
    v_mfma_f32_16x16x32_bf16 v[32:35], v[112:115], v[108:111], v[32:35]
    ds_read_b64_tr_b16 v[84:85], v9 offset:0
    v_mfma_f32_16x16x32_bf16 v[36:39], v[116:119], v[96:99], v[36:39]
    ds_read_b64_tr_b16 v[86:87], v9 offset:1536
    v_mfma_f32_16x16x32_bf16 v[40:43], v[116:119], v[100:103], v[40:43]
    ds_read_b128 v[68:71], v8 offset:24576
    ds_read_b128 v[72:75], v8 offset:26624
    v_mfma_f32_16x16x32_bf16 v[44:47], v[116:119], v[104:107], v[44:47]
    s_add_u32 m0, s67, 25600
    s_nop 0
    buffer_load_dwordx4 v13, s[20:23], s56 offen lds
    v_mfma_f32_16x16x32_bf16 v[48:51], v[116:119], v[108:111], v[48:51]
    ds_read_b128 v[76:79], v8 offset:28672
    v_mfma_f32_16x16x32_bf16 v[52:55], v[120:123], v[96:99], v[52:55]
    ds_read_b128 v[80:83], v8 offset:30720
    ds_read_b64_tr_b16 v[88:89], v10 offset:0
    v_mfma_f32_16x16x32_bf16 v[56:59], v[120:123], v[100:103], v[56:59]
    ds_read_b64_tr_b16 v[90:91], v10 offset:1536
    v_mfma_f32_16x16x32_bf16 v[60:63], v[120:123], v[104:107], v[60:63]
    s_add_u32 m0, s67, 26624
    s_nop 0
    buffer_load_dwordx4 v14, s[20:23], s56 offen lds
    v_mfma_f32_16x16x32_bf16 v[64:67], v[120:123], v[108:111], v[64:67]
    ds_read_b64_tr_b16 v[92:93], v11 offset:0
    ds_read_b64_tr_b16 v[94:95], v11 offset:1536
    s_waitcnt lgkmcnt(10)
    v_mfma_f32_16x16x32_bf16 v[20:23], v[140:143], v[124:127], v[20:23]
    ds_read_b64_tr_b16 v[112:113], v9 offset:12288
    v_mfma_f32_16x16x32_bf16 v[24:27], v[140:143], v[128:131], v[24:27]
    ds_read_b64_tr_b16 v[114:115], v9 offset:13824
    v_mfma_f32_16x16x32_bf16 v[28:31], v[140:143], v[132:135], v[28:31]
    s_add_u32 m0, s67, 27648
    s_nop 0
    buffer_load_dwordx4 v15, s[20:23], s56 offen lds
    v_mfma_f32_16x16x32_bf16 v[32:35], v[140:143], v[136:139], v[32:35]
    ds_read_b128 v[96:99], v8 offset:25600
    v_mfma_f32_16x16x32_bf16 v[36:39], v[144:147], v[124:127], v[36:39]
    ds_read_b128 v[100:103], v8 offset:27648
    v_mfma_f32_16x16x32_bf16 v[40:43], v[144:147], v[128:131], v[40:43]
    ds_read_b128 v[104:107], v8 offset:29696
    v_mfma_f32_16x16x32_bf16 v[44:47], v[144:147], v[132:135], v[44:47]
    s_add_u32 m0, s67, 28672
    s_nop 0
    buffer_load_dwordx4 v16, s[20:23], s56 offen lds
    v_mfma_f32_16x16x32_bf16 v[48:51], v[144:147], v[136:139], v[48:51]
    ds_read_b128 v[108:111], v8 offset:31744
    v_mfma_f32_16x16x32_bf16 v[52:55], v[148:151], v[124:127], v[52:55]
    ds_read_b64_tr_b16 v[116:117], v10 offset:12288
    v_mfma_f32_16x16x32_bf16 v[56:59], v[148:151], v[128:131], v[56:59]
    ds_read_b64_tr_b16 v[118:119], v10 offset:13824
    v_mfma_f32_16x16x32_bf16 v[60:63], v[148:151], v[132:135], v[60:63]
    s_add_u32 m0, s67, 29696
    s_nop 0
    buffer_load_dwordx4 v17, s[20:23], s56 offen lds
    v_mfma_f32_16x16x32_bf16 v[64:67], v[148:151], v[136:139], v[64:67]
    ds_read_b64_tr_b16 v[120:121], v11 offset:12288
    ds_read_b64_tr_b16 v[122:123], v11 offset:13824
    s_waitcnt vmcnt(12)
    s_barrier
    s_waitcnt lgkmcnt(10)
    v_mfma_f32_16x16x32_bf16 v[20:23], v[84:87], v[68:71], v[20:23]
    v_add_u32 v9, 24576, v9
    v_mfma_f32_16x16x32_bf16 v[24:27], v[84:87], v[72:75], v[24:27]
    v_add_u32 v10, 24576, v10
    v_mfma_f32_16x16x32_bf16 v[28:31], v[84:87], v[76:79], v[28:31]
    s_mov_b32 s56, 1232896
    s_add_u32 m0, s67, 49152
    s_nop 0
    buffer_load_dwordx4 v12, s[20:23], s56 offen lds
    v_add_u32 v11, 24576, v11
    v_mfma_f32_16x16x32_bf16 v[32:35], v[84:87], v[80:83], v[32:35]
    ds_read_b64_tr_b16 v[140:141], v9 offset:0
    v_mfma_f32_16x16x32_bf16 v[36:39], v[88:91], v[68:71], v[36:39]
    ds_read_b64_tr_b16 v[142:143], v9 offset:1536
    v_mfma_f32_16x16x32_bf16 v[40:43], v[88:91], v[72:75], v[40:43]
    ds_read_b128 v[124:127], v8 offset:0
    ds_read_b128 v[128:131], v8 offset:2048
    v_mfma_f32_16x16x32_bf16 v[44:47], v[88:91], v[76:79], v[44:47]
    s_add_u32 m0, s67, 50176
    s_nop 0
    buffer_load_dwordx4 v13, s[20:23], s56 offen lds
    v_mfma_f32_16x16x32_bf16 v[48:51], v[88:91], v[80:83], v[48:51]
    ds_read_b128 v[132:135], v8 offset:4096
    v_mfma_f32_16x16x32_bf16 v[52:55], v[92:95], v[68:71], v[52:55]
    ds_read_b128 v[136:139], v8 offset:6144
    ds_read_b64_tr_b16 v[144:145], v10 offset:0
    v_mfma_f32_16x16x32_bf16 v[56:59], v[92:95], v[72:75], v[56:59]
    ds_read_b64_tr_b16 v[146:147], v10 offset:1536
    v_mfma_f32_16x16x32_bf16 v[60:63], v[92:95], v[76:79], v[60:63]
    s_add_u32 m0, s67, 51200
    s_nop 0
    buffer_load_dwordx4 v14, s[20:23], s56 offen lds
    v_mfma_f32_16x16x32_bf16 v[64:67], v[92:95], v[80:83], v[64:67]
    ds_read_b64_tr_b16 v[148:149], v11 offset:0
    ds_read_b64_tr_b16 v[150:151], v11 offset:1536
    s_waitcnt lgkmcnt(10)
    v_mfma_f32_16x16x32_bf16 v[20:23], v[112:115], v[96:99], v[20:23]
    ds_read_b64_tr_b16 v[84:85], v9 offset:12288
    v_mfma_f32_16x16x32_bf16 v[24:27], v[112:115], v[100:103], v[24:27]
    ds_read_b64_tr_b16 v[86:87], v9 offset:13824
    v_mfma_f32_16x16x32_bf16 v[28:31], v[112:115], v[104:107], v[28:31]
    s_add_u32 m0, s67, 52224
    s_nop 0
    buffer_load_dwordx4 v15, s[20:23], s56 offen lds
    v_mfma_f32_16x16x32_bf16 v[32:35], v[112:115], v[108:111], v[32:35]
    ds_read_b128 v[68:71], v8 offset:1024
    v_mfma_f32_16x16x32_bf16 v[36:39], v[116:119], v[96:99], v[36:39]
    ds_read_b128 v[72:75], v8 offset:3072
    v_mfma_f32_16x16x32_bf16 v[40:43], v[116:119], v[100:103], v[40:43]
    ds_read_b128 v[76:79], v8 offset:5120
    v_mfma_f32_16x16x32_bf16 v[44:47], v[116:119], v[104:107], v[44:47]
    s_add_u32 m0, s67, 53248
    s_nop 0
    buffer_load_dwordx4 v16, s[20:23], s56 offen lds
    v_mfma_f32_16x16x32_bf16 v[48:51], v[116:119], v[108:111], v[48:51]
    ds_read_b128 v[80:83], v8 offset:7168
    v_mfma_f32_16x16x32_bf16 v[52:55], v[120:123], v[96:99], v[52:55]
    ds_read_b64_tr_b16 v[88:89], v10 offset:12288
    v_mfma_f32_16x16x32_bf16 v[56:59], v[120:123], v[100:103], v[56:59]
    ds_read_b64_tr_b16 v[90:91], v10 offset:13824
    v_mfma_f32_16x16x32_bf16 v[60:63], v[120:123], v[104:107], v[60:63]
    s_add_u32 m0, s67, 54272
    s_nop 0
    buffer_load_dwordx4 v17, s[20:23], s56 offen lds
    v_mfma_f32_16x16x32_bf16 v[64:67], v[120:123], v[108:111], v[64:67]
    ds_read_b64_tr_b16 v[92:93], v11 offset:12288
    ds_read_b64_tr_b16 v[94:95], v11 offset:13824
    s_waitcnt vmcnt(12)
    s_barrier
    s_waitcnt lgkmcnt(10)
    v_mfma_f32_16x16x32_bf16 v[20:23], v[140:143], v[124:127], v[20:23]
    v_add_u32 v9, 4294868992, v9
    v_mfma_f32_16x16x32_bf16 v[24:27], v[140:143], v[128:131], v[24:27]
    v_add_u32 v10, 4294868992, v10
    v_mfma_f32_16x16x32_bf16 v[28:31], v[140:143], v[132:135], v[28:31]
    v_add_u32 v11, 4294868992, v11
    v_mfma_f32_16x16x32_bf16 v[32:35], v[140:143], v[136:139], v[32:35]
    ds_read_b64_tr_b16 v[112:113], v9 offset:0
    v_mfma_f32_16x16x32_bf16 v[36:39], v[144:147], v[124:127], v[36:39]
    ds_read_b64_tr_b16 v[114:115], v9 offset:1536
    v_mfma_f32_16x16x32_bf16 v[40:43], v[144:147], v[128:131], v[40:43]
    ds_read_b128 v[96:99], v8 offset:8192
    v_mfma_f32_16x16x32_bf16 v[44:47], v[144:147], v[132:135], v[44:47]
    ds_read_b128 v[100:103], v8 offset:10240
    v_mfma_f32_16x16x32_bf16 v[48:51], v[144:147], v[136:139], v[48:51]
    ds_read_b128 v[104:107], v8 offset:12288
    v_mfma_f32_16x16x32_bf16 v[52:55], v[148:151], v[124:127], v[52:55]
    ds_read_b128 v[108:111], v8 offset:14336
    v_mfma_f32_16x16x32_bf16 v[56:59], v[148:151], v[128:131], v[56:59]
    ds_read_b64_tr_b16 v[116:117], v10 offset:0
    v_mfma_f32_16x16x32_bf16 v[60:63], v[148:151], v[132:135], v[60:63]
    ds_read_b64_tr_b16 v[118:119], v10 offset:1536
    v_mfma_f32_16x16x32_bf16 v[64:67], v[148:151], v[136:139], v[64:67]
    ds_read_b64_tr_b16 v[120:121], v11 offset:0
    ds_read_b64_tr_b16 v[122:123], v11 offset:1536
    s_waitcnt lgkmcnt(10)
    v_mfma_f32_16x16x32_bf16 v[20:23], v[84:87], v[68:71], v[20:23]
    v_mfma_f32_16x16x32_bf16 v[24:27], v[84:87], v[72:75], v[24:27]
    ds_read_b64_tr_b16 v[140:141], v9 offset:12288
    v_mfma_f32_16x16x32_bf16 v[28:31], v[84:87], v[76:79], v[28:31]
    ds_read_b64_tr_b16 v[142:143], v9 offset:13824
    v_mfma_f32_16x16x32_bf16 v[32:35], v[84:87], v[80:83], v[32:35]
    ds_read_b128 v[124:127], v8 offset:9216
    v_mfma_f32_16x16x32_bf16 v[36:39], v[88:91], v[68:71], v[36:39]
    ds_read_b128 v[128:131], v8 offset:11264
    v_mfma_f32_16x16x32_bf16 v[40:43], v[88:91], v[72:75], v[40:43]
    ds_read_b128 v[132:135], v8 offset:13312
    v_mfma_f32_16x16x32_bf16 v[44:47], v[88:91], v[76:79], v[44:47]
    v_mfma_f32_16x16x32_bf16 v[48:51], v[88:91], v[80:83], v[48:51]
    ds_read_b128 v[136:139], v8 offset:15360
    v_mfma_f32_16x16x32_bf16 v[52:55], v[92:95], v[68:71], v[52:55]
    ds_read_b64_tr_b16 v[144:145], v10 offset:12288
    v_mfma_f32_16x16x32_bf16 v[56:59], v[92:95], v[72:75], v[56:59]
    ds_read_b64_tr_b16 v[146:147], v10 offset:13824
    v_mfma_f32_16x16x32_bf16 v[60:63], v[92:95], v[76:79], v[60:63]
    ds_read_b64_tr_b16 v[148:149], v11 offset:12288
    v_mfma_f32_16x16x32_bf16 v[64:67], v[92:95], v[80:83], v[64:67]
    ds_read_b64_tr_b16 v[150:151], v11 offset:13824
    s_waitcnt vmcnt(6)
    s_barrier
    s_waitcnt lgkmcnt(10)
    v_mfma_f32_16x16x32_bf16 v[20:23], v[112:115], v[96:99], v[20:23]
    v_add_u32 v9, 24576, v9
    v_mfma_f32_16x16x32_bf16 v[24:27], v[112:115], v[100:103], v[24:27]
    v_add_u32 v10, 24576, v10
    v_mfma_f32_16x16x32_bf16 v[28:31], v[112:115], v[104:107], v[28:31]
    v_add_u32 v11, 24576, v11
    v_mfma_f32_16x16x32_bf16 v[32:35], v[112:115], v[108:111], v[32:35]
    ds_read_b64_tr_b16 v[84:85], v9 offset:0
    v_mfma_f32_16x16x32_bf16 v[36:39], v[116:119], v[96:99], v[36:39]
    ds_read_b64_tr_b16 v[86:87], v9 offset:1536
    v_mfma_f32_16x16x32_bf16 v[40:43], v[116:119], v[100:103], v[40:43]
    ds_read_b128 v[68:71], v8 offset:16384
    v_mfma_f32_16x16x32_bf16 v[44:47], v[116:119], v[104:107], v[44:47]
    ds_read_b128 v[72:75], v8 offset:18432
    v_mfma_f32_16x16x32_bf16 v[48:51], v[116:119], v[108:111], v[48:51]
    ds_read_b128 v[76:79], v8 offset:20480
    v_mfma_f32_16x16x32_bf16 v[52:55], v[120:123], v[96:99], v[52:55]
    ds_read_b128 v[80:83], v8 offset:22528
    v_mfma_f32_16x16x32_bf16 v[56:59], v[120:123], v[100:103], v[56:59]
    ds_read_b64_tr_b16 v[88:89], v10 offset:0
    v_mfma_f32_16x16x32_bf16 v[60:63], v[120:123], v[104:107], v[60:63]
    ds_read_b64_tr_b16 v[90:91], v10 offset:1536
    v_mfma_f32_16x16x32_bf16 v[64:67], v[120:123], v[108:111], v[64:67]
    ds_read_b64_tr_b16 v[92:93], v11 offset:0
    ds_read_b64_tr_b16 v[94:95], v11 offset:1536
    s_waitcnt lgkmcnt(10)
    v_mfma_f32_16x16x32_bf16 v[20:23], v[140:143], v[124:127], v[20:23]
    v_mfma_f32_16x16x32_bf16 v[24:27], v[140:143], v[128:131], v[24:27]
    ds_read_b64_tr_b16 v[112:113], v9 offset:12288
    v_mfma_f32_16x16x32_bf16 v[28:31], v[140:143], v[132:135], v[28:31]
    ds_read_b64_tr_b16 v[114:115], v9 offset:13824
    v_mfma_f32_16x16x32_bf16 v[32:35], v[140:143], v[136:139], v[32:35]
    ds_read_b128 v[96:99], v8 offset:17408
    v_mfma_f32_16x16x32_bf16 v[36:39], v[144:147], v[124:127], v[36:39]
    ds_read_b128 v[100:103], v8 offset:19456
    v_mfma_f32_16x16x32_bf16 v[40:43], v[144:147], v[128:131], v[40:43]
    ds_read_b128 v[104:107], v8 offset:21504
    v_mfma_f32_16x16x32_bf16 v[44:47], v[144:147], v[132:135], v[44:47]
    v_mfma_f32_16x16x32_bf16 v[48:51], v[144:147], v[136:139], v[48:51]
    ds_read_b128 v[108:111], v8 offset:23552
    v_mfma_f32_16x16x32_bf16 v[52:55], v[148:151], v[124:127], v[52:55]
    ds_read_b64_tr_b16 v[116:117], v10 offset:12288
    v_mfma_f32_16x16x32_bf16 v[56:59], v[148:151], v[128:131], v[56:59]
    ds_read_b64_tr_b16 v[118:119], v10 offset:13824
    v_mfma_f32_16x16x32_bf16 v[60:63], v[148:151], v[132:135], v[60:63]
    ds_read_b64_tr_b16 v[120:121], v11 offset:12288
    v_mfma_f32_16x16x32_bf16 v[64:67], v[148:151], v[136:139], v[64:67]
    ds_read_b64_tr_b16 v[122:123], v11 offset:13824
    s_waitcnt vmcnt(0)
    s_barrier
    s_waitcnt lgkmcnt(10)
    v_mfma_f32_16x16x32_bf16 v[20:23], v[84:87], v[68:71], v[20:23]
    v_add_u32 v9, 24576, v9
    v_mfma_f32_16x16x32_bf16 v[24:27], v[84:87], v[72:75], v[24:27]
    v_add_u32 v10, 24576, v10
    v_mfma_f32_16x16x32_bf16 v[28:31], v[84:87], v[76:79], v[28:31]
    v_add_u32 v11, 24576, v11
    v_mfma_f32_16x16x32_bf16 v[32:35], v[84:87], v[80:83], v[32:35]
    ds_read_b64_tr_b16 v[140:141], v9 offset:0
    v_mfma_f32_16x16x32_bf16 v[36:39], v[88:91], v[68:71], v[36:39]
    ds_read_b64_tr_b16 v[142:143], v9 offset:1536
    v_mfma_f32_16x16x32_bf16 v[40:43], v[88:91], v[72:75], v[40:43]
    ds_read_b128 v[124:127], v8 offset:24576
    v_mfma_f32_16x16x32_bf16 v[44:47], v[88:91], v[76:79], v[44:47]
    ds_read_b128 v[128:131], v8 offset:26624
    v_mfma_f32_16x16x32_bf16 v[48:51], v[88:91], v[80:83], v[48:51]
    ds_read_b128 v[132:135], v8 offset:28672
    v_mfma_f32_16x16x32_bf16 v[52:55], v[92:95], v[68:71], v[52:55]
    ds_read_b128 v[136:139], v8 offset:30720
    v_mfma_f32_16x16x32_bf16 v[56:59], v[92:95], v[72:75], v[56:59]
    ds_read_b64_tr_b16 v[144:145], v10 offset:0
    v_mfma_f32_16x16x32_bf16 v[60:63], v[92:95], v[76:79], v[60:63]
    ds_read_b64_tr_b16 v[146:147], v10 offset:1536
    v_mfma_f32_16x16x32_bf16 v[64:67], v[92:95], v[80:83], v[64:67]
    ds_read_b64_tr_b16 v[148:149], v11 offset:0
    ds_read_b64_tr_b16 v[150:151], v11 offset:1536
    s_waitcnt lgkmcnt(10)
    v_mfma_f32_16x16x32_bf16 v[20:23], v[112:115], v[96:99], v[20:23]
    v_mfma_f32_16x16x32_bf16 v[24:27], v[112:115], v[100:103], v[24:27]
    ds_read_b64_tr_b16 v[84:85], v9 offset:12288
    v_mfma_f32_16x16x32_bf16 v[28:31], v[112:115], v[104:107], v[28:31]
    ds_read_b64_tr_b16 v[86:87], v9 offset:13824
    v_mfma_f32_16x16x32_bf16 v[32:35], v[112:115], v[108:111], v[32:35]
    ds_read_b128 v[68:71], v8 offset:25600
    v_mfma_f32_16x16x32_bf16 v[36:39], v[116:119], v[96:99], v[36:39]
    ds_read_b128 v[72:75], v8 offset:27648
    v_mfma_f32_16x16x32_bf16 v[40:43], v[116:119], v[100:103], v[40:43]
    ds_read_b128 v[76:79], v8 offset:29696
    v_mfma_f32_16x16x32_bf16 v[44:47], v[116:119], v[104:107], v[44:47]
    v_mfma_f32_16x16x32_bf16 v[48:51], v[116:119], v[108:111], v[48:51]
    ds_read_b128 v[80:83], v8 offset:31744
    v_mfma_f32_16x16x32_bf16 v[52:55], v[120:123], v[96:99], v[52:55]
    ds_read_b64_tr_b16 v[88:89], v10 offset:12288
    v_mfma_f32_16x16x32_bf16 v[56:59], v[120:123], v[100:103], v[56:59]
    ds_read_b64_tr_b16 v[90:91], v10 offset:13824
    v_mfma_f32_16x16x32_bf16 v[60:63], v[120:123], v[104:107], v[60:63]
    ds_read_b64_tr_b16 v[92:93], v11 offset:12288
    v_mfma_f32_16x16x32_bf16 v[64:67], v[120:123], v[108:111], v[64:67]
    ds_read_b64_tr_b16 v[94:95], v11 offset:13824
    s_waitcnt lgkmcnt(10)
    v_mfma_f32_16x16x32_bf16 v[20:23], v[140:143], v[124:127], v[20:23]
    v_mfma_f32_16x16x32_bf16 v[24:27], v[140:143], v[128:131], v[24:27]
    v_mfma_f32_16x16x32_bf16 v[28:31], v[140:143], v[132:135], v[28:31]
    v_mfma_f32_16x16x32_bf16 v[32:35], v[140:143], v[136:139], v[32:35]
    v_mfma_f32_16x16x32_bf16 v[36:39], v[144:147], v[124:127], v[36:39]
    v_mfma_f32_16x16x32_bf16 v[40:43], v[144:147], v[128:131], v[40:43]
    v_mfma_f32_16x16x32_bf16 v[44:47], v[144:147], v[132:135], v[44:47]
    v_mfma_f32_16x16x32_bf16 v[48:51], v[144:147], v[136:139], v[48:51]
    v_mfma_f32_16x16x32_bf16 v[52:55], v[148:151], v[124:127], v[52:55]
    v_mfma_f32_16x16x32_bf16 v[56:59], v[148:151], v[128:131], v[56:59]
    v_mfma_f32_16x16x32_bf16 v[60:63], v[148:151], v[132:135], v[60:63]
    v_mfma_f32_16x16x32_bf16 v[64:67], v[148:151], v[136:139], v[64:67]
    s_waitcnt lgkmcnt(0)
    v_mfma_f32_16x16x32_bf16 v[20:23], v[84:87], v[68:71], v[20:23]
    v_mfma_f32_16x16x32_bf16 v[24:27], v[84:87], v[72:75], v[24:27]
    v_mfma_f32_16x16x32_bf16 v[28:31], v[84:87], v[76:79], v[28:31]
    v_mfma_f32_16x16x32_bf16 v[32:35], v[84:87], v[80:83], v[32:35]
    v_mfma_f32_16x16x32_bf16 v[36:39], v[88:91], v[68:71], v[36:39]
    v_mfma_f32_16x16x32_bf16 v[40:43], v[88:91], v[72:75], v[40:43]
    v_mfma_f32_16x16x32_bf16 v[44:47], v[88:91], v[76:79], v[44:47]
    v_mfma_f32_16x16x32_bf16 v[48:51], v[88:91], v[80:83], v[48:51]
    v_mfma_f32_16x16x32_bf16 v[52:55], v[92:95], v[68:71], v[52:55]
    v_mfma_f32_16x16x32_bf16 v[56:59], v[92:95], v[72:75], v[56:59]
    v_mfma_f32_16x16x32_bf16 v[60:63], v[92:95], v[76:79], v[60:63]
    v_mfma_f32_16x16x32_bf16 v[64:67], v[92:95], v[80:83], v[64:67]
    s_waitcnt lgkmcnt(0)
    v_cvt_pk_bf16_f32 v68, v20, v21
    v_cvt_pk_bf16_f32 v69, v22, v23
    v_cvt_pk_bf16_f32 v70, v24, v25
    v_cvt_pk_bf16_f32 v71, v26, v27
    v_cvt_pk_bf16_f32 v72, v28, v29
    v_cvt_pk_bf16_f32 v73, v30, v31
    v_cvt_pk_bf16_f32 v74, v32, v33
    v_cvt_pk_bf16_f32 v75, v34, v35
    v_cvt_pk_bf16_f32 v76, v36, v37
    v_cvt_pk_bf16_f32 v77, v38, v39
    v_cvt_pk_bf16_f32 v78, v40, v41
    v_cvt_pk_bf16_f32 v79, v42, v43
    v_cvt_pk_bf16_f32 v80, v44, v45
    v_cvt_pk_bf16_f32 v81, v46, v47
    v_cvt_pk_bf16_f32 v82, v48, v49
    v_cvt_pk_bf16_f32 v83, v50, v51
    v_cvt_pk_bf16_f32 v84, v52, v53
    v_cvt_pk_bf16_f32 v85, v54, v55
    v_cvt_pk_bf16_f32 v86, v56, v57
    v_cvt_pk_bf16_f32 v87, v58, v59
    v_cvt_pk_bf16_f32 v88, v60, v61
    v_cvt_pk_bf16_f32 v89, v62, v63
    v_cvt_pk_bf16_f32 v90, v64, v65
    v_cvt_pk_bf16_f32 v91, v66, v67
    v_pk_max_i16 v68, v68, 0
    v_pk_max_i16 v69, v69, 0
    v_pk_max_i16 v70, v70, 0
    v_pk_max_i16 v71, v71, 0
    v_pk_max_i16 v72, v72, 0
    v_pk_max_i16 v73, v73, 0
    v_pk_max_i16 v74, v74, 0
    v_pk_max_i16 v75, v75, 0
    v_pk_max_i16 v76, v76, 0
    v_pk_max_i16 v77, v77, 0
    v_pk_max_i16 v78, v78, 0
    v_pk_max_i16 v79, v79, 0
    v_pk_max_i16 v80, v80, 0
    v_pk_max_i16 v81, v81, 0
    v_pk_max_i16 v82, v82, 0
    v_pk_max_i16 v83, v83, 0
    v_pk_max_i16 v84, v84, 0
    v_pk_max_i16 v85, v85, 0
    v_pk_max_i16 v86, v86, 0
    v_pk_max_i16 v87, v87, 0
    v_pk_max_i16 v88, v88, 0
    v_pk_max_i16 v89, v89, 0
    v_pk_max_i16 v90, v90, 0
    v_pk_max_i16 v91, v91, 0
    buffer_store_dwordx2 v[68:69], v168, s[36:39], 0 offen offset:0 sc1
    buffer_store_dwordx2 v[70:71], v169, s[36:39], 0 offen offset:0 sc1
    buffer_store_dwordx2 v[72:73], v170, s[36:39], 0 offen offset:0 sc1
    buffer_store_dwordx2 v[74:75], v171, s[36:39], 0 offen offset:0 sc1
    buffer_store_dwordx2 v[76:77], v168, s[36:39], s73 offen offset:512 sc1
    buffer_store_dwordx2 v[78:79], v169, s[36:39], s73 offen offset:512 sc1
    buffer_store_dwordx2 v[80:81], v170, s[36:39], s73 offen offset:512 sc1
    buffer_store_dwordx2 v[82:83], v171, s[36:39], s73 offen offset:512 sc1
    buffer_store_dwordx2 v[84:85], v168, s[36:39], s74 offen offset:1024 sc1
    buffer_store_dwordx2 v[86:87], v169, s[36:39], s74 offen offset:1024 sc1
    buffer_store_dwordx2 v[88:89], v170, s[36:39], s74 offen offset:1024 sc1
    buffer_store_dwordx2 v[90:91], v171, s[36:39], s74 offen offset:1024 sc1
    s_barrier
    v_and_b32 v8, 15, v1
    v_lshrrev_b32 v9, 4, v1
    v_lshlrev_b32 v10, 4, v9
    v_lshlrev_b32 v11, 5, v8
    v_sub_u32 v10, v10, v11
    s_lshr_b32 s55, s59, 1
    s_and_b32 s56, s59, 1
    s_mul_i32 s57, s55, 4608
    s_add_u32 s57, s57, 140384
    s_lshl_b32 s4, s56, 6
    s_add_u32 s57, s57, s4
    v_add_u32 v2, s57, v10
    v_and_b32 v10, 3, v8
    v_mul_u32_u24 v10, 4160, v10
    v_lshrrev_b32 v11, 2, v8
    v_lshl_add_u32 v10, v11, 3, v10
    v_lshl_add_u32 v10, v9, 4, v10
    s_mul_i32 s57, s55, 16640
    s_add_u32 s57, s57, s4
    s_add_u32 s57, s57, 106504
    v_add_u32 v3, s57, v10
    v_lshl_add_u32 v10, v9, 3, v8
    s_lshl_b32 s4, s56, 5
    v_add_u32 v10, s4, v10
    v_sub_u32 v11, 15, v10
    v_med3_i32 v11, v11, 0, 2
    v_lshlrev_b32 v11, 4, v11
    v_mov_b32 v12, -1
    v_lshlrev_b32 v16, v11, v12
    v_cmp_eq_u32 vcc, 32, v11
    s_nop 1
    v_cndmask_b32_e64 v12, v16, 0, vcc
    v_sub_u32 v11, 13, v10
    v_med3_i32 v11, v11, 0, 2
    v_lshlrev_b32 v11, 4, v11
    v_mov_b32 v13, -1
    v_lshlrev_b32 v16, v11, v13
    v_cmp_eq_u32 vcc, 32, v11
    s_nop 1
    v_cndmask_b32_e64 v13, v16, 0, vcc
    v_sub_u32 v11, 11, v10
    v_med3_i32 v11, v11, 0, 2
    v_lshlrev_b32 v11, 4, v11
    v_mov_b32 v14, -1
    v_lshlrev_b32 v16, v11, v14
    v_cmp_eq_u32 vcc, 32, v11
    s_nop 1
    v_cndmask_b32_e64 v14, v16, 0, vcc
    v_sub_u32 v11, 9, v10
    v_med3_i32 v11, v11, 0, 2
    v_lshlrev_b32 v11, 4, v11
    v_mov_b32 v15, -1
    v_lshlrev_b32 v16, v11, v15
    v_cmp_eq_u32 vcc, 32, v11
    s_nop 1
    v_cndmask_b32_e64 v15, v16, 0, vcc
    v_mov_b32 v148, 0
    v_mov_b32 v149, 0
    v_mov_b32 v150, 0
    v_mov_b32 v151, 0
    v_mov_b32 v152, 0
    v_mov_b32 v153, 0
    v_mov_b32 v154, 0
    v_mov_b32 v155, 0
    v_mov_b32 v156, 0
    v_mov_b32 v157, 0
    v_mov_b32 v158, 0
    v_mov_b32 v159, 0
    v_mov_b32 v160, 0
    v_mov_b32 v161, 0
    v_mov_b32 v162, 0
    v_mov_b32 v163, 0
    v_mov_b32 v164, 0
    v_mov_b32 v165, 0
    v_mov_b32 v166, 0
    v_mov_b32 v167, 0
    v_mov_b32 v168, 0
    v_mov_b32 v169, 0
    v_mov_b32 v170, 0
    v_mov_b32 v171, 0
    v_mov_b32 v172, 0
    v_mov_b32 v173, 0
    v_mov_b32 v174, 0
    v_mov_b32 v175, 0
    v_mov_b32 v176, 0
    v_mov_b32 v177, 0
    v_mov_b32 v178, 0
    v_mov_b32 v179, 0
    ds_read_b64 v[180:181], v3 offset:0
    ds_read_b64 v[182:183], v3 offset:8
    ds_read_b128 v[20:23], v2 offset:0
    ds_read_b128 v[36:39], v2 offset:512
    ds_read_b128 v[52:55], v2 offset:1024
    ds_read_b128 v[68:71], v2 offset:1536
    ds_read_b128 v[84:87], v2 offset:2048
    ds_read_b128 v[100:103], v2 offset:2560
    ds_read_b128 v[116:119], v2 offset:3072
    ds_read_b128 v[132:135], v2 offset:3584
    ds_read_b64 v[184:185], v3 offset:128
    ds_read_b64 v[186:187], v3 offset:136
    ds_read_b128 v[24:27], v2 offset:128
    ds_read_b128 v[40:43], v2 offset:640
    s_waitcnt lgkmcnt(8)
    v_and_b32 v180, v12, v180
    v_and_b32 v181, v13, v181
    v_and_b32 v182, v14, v182
    v_and_b32 v183, v15, v183
    s_nop 1
    v_mfma_f32_16x16x32_bf16 v[176:179], v[180:183], v[20:23], v[176:179]
    ds_read_b128 v[56:59], v2 offset:1152
    ds_read_b128 v[72:75], v2 offset:1664
    v_mfma_f32_16x16x32_bf16 v[172:175], v[180:183], v[36:39], v[172:175]
    ds_read_b128 v[88:91], v2 offset:2176
    ds_read_b128 v[104:107], v2 offset:2688
    v_mfma_f32_16x16x32_bf16 v[168:171], v[180:183], v[52:55], v[168:171]
    ds_read_b128 v[120:123], v2 offset:3200
    ds_read_b128 v[136:139], v2 offset:3712
    v_mfma_f32_16x16x32_bf16 v[164:167], v[180:183], v[68:71], v[164:167]
    s_waitcnt lgkmcnt(10)
    v_mfma_f32_16x16x32_bf16 v[160:163], v[180:183], v[84:87], v[160:163]
    ds_read_b64 v[188:189], v3 offset:256
    ds_read_b64 v[190:191], v3 offset:264
    ds_read_b128 v[28:31], v2 offset:256
    v_mfma_f32_16x16x32_bf16 v[156:159], v[180:183], v[100:103], v[156:159]
    ds_read_b128 v[44:47], v2 offset:768
    v_mfma_f32_16x16x32_bf16 v[152:155], v[180:183], v[116:119], v[152:155]
    v_mfma_f32_16x16x32_bf16 v[148:151], v[180:183], v[132:135], v[148:151]
    s_waitcnt lgkmcnt(8)
    v_mfma_f32_16x16x32_bf16 v[176:179], v[184:187], v[24:27], v[176:179]
    ds_read_b128 v[60:63], v2 offset:1280
    ds_read_b128 v[76:79], v2 offset:1792
    v_mfma_f32_16x16x32_bf16 v[172:175], v[184:187], v[40:43], v[172:175]
    ds_read_b128 v[92:95], v2 offset:2304
    ds_read_b128 v[108:111], v2 offset:2816
    v_mfma_f32_16x16x32_bf16 v[168:171], v[184:187], v[56:59], v[168:171]
    ds_read_b128 v[124:127], v2 offset:3328
    ds_read_b128 v[140:143], v2 offset:3840
    v_mfma_f32_16x16x32_bf16 v[164:167], v[184:187], v[72:75], v[164:167]
    s_waitcnt lgkmcnt(10)
    v_mfma_f32_16x16x32_bf16 v[160:163], v[184:187], v[88:91], v[160:163]
    ds_read_b64 v[192:193], v3 offset:384
    ds_read_b64 v[194:195], v3 offset:392
    ds_read_b128 v[32:35], v2 offset:384
    v_mfma_f32_16x16x32_bf16 v[156:159], v[184:187], v[104:107], v[156:159]
    ds_read_b128 v[48:51], v2 offset:896
    v_mfma_f32_16x16x32_bf16 v[152:155], v[184:187], v[120:123], v[152:155]
    v_mfma_f32_16x16x32_bf16 v[148:151], v[184:187], v[136:139], v[148:151]
    s_waitcnt lgkmcnt(8)
    v_mfma_f32_16x16x32_bf16 v[176:179], v[188:191], v[28:31], v[176:179]
    ds_read_b128 v[64:67], v2 offset:1408
    ds_read_b128 v[80:83], v2 offset:1920
    v_mfma_f32_16x16x32_bf16 v[172:175], v[188:191], v[44:47], v[172:175]
    ds_read_b128 v[96:99], v2 offset:2432
    ds_read_b128 v[112:115], v2 offset:2944
    v_mfma_f32_16x16x32_bf16 v[168:171], v[188:191], v[60:63], v[168:171]
    ds_read_b128 v[128:131], v2 offset:3456
    ds_read_b128 v[144:147], v2 offset:3968
    v_mfma_f32_16x16x32_bf16 v[164:167], v[188:191], v[76:79], v[164:167]
    s_waitcnt lgkmcnt(10)
    v_mfma_f32_16x16x32_bf16 v[160:163], v[188:191], v[92:95], v[160:163]
    ds_read_b64 v[196:197], v3 offset:512
    ds_read_b64 v[198:199], v3 offset:520
    ds_read_b64 v[200:201], v3 offset:640
    ds_read_b64 v[202:203], v3 offset:648
    v_mfma_f32_16x16x32_bf16 v[156:159], v[188:191], v[108:111], v[156:159]
    v_mfma_f32_16x16x32_bf16 v[152:155], v[188:191], v[124:127], v[152:155]
    v_mfma_f32_16x16x32_bf16 v[148:151], v[188:191], v[140:143], v[148:151]
    s_waitcnt lgkmcnt(8)
    v_mfma_f32_16x16x32_bf16 v[176:179], v[192:195], v[32:35], v[176:179]
    ds_read_b64 v[204:205], v3 offset:768
    ds_read_b64 v[206:207], v3 offset:776
    ds_read_b64 v[208:209], v3 offset:896
    ds_read_b64 v[210:211], v3 offset:904
    v_mfma_f32_16x16x32_bf16 v[172:175], v[192:195], v[48:51], v[172:175]
    ds_read_b64 v[212:213], v3 offset:1024
    ds_read_b64 v[214:215], v3 offset:1032
    v_mfma_f32_16x16x32_bf16 v[168:171], v[192:195], v[64:67], v[168:171]
    v_mfma_f32_16x16x32_bf16 v[164:167], v[192:195], v[80:83], v[164:167]
    s_waitcnt lgkmcnt(10)
    v_mfma_f32_16x16x32_bf16 v[160:163], v[192:195], v[96:99], v[160:163]
    ds_read_b64 v[216:217], v3 offset:1152
    ds_read_b64 v[218:219], v3 offset:1160
    ds_read_b64 v[220:221], v3 offset:1280
    ds_read_b64 v[222:223], v3 offset:1288
    v_mfma_f32_16x16x32_bf16 v[156:159], v[192:195], v[112:115], v[156:159]
    v_mfma_f32_16x16x32_bf16 v[152:155], v[192:195], v[128:131], v[152:155]
    v_mfma_f32_16x16x32_bf16 v[148:151], v[192:195], v[144:147], v[148:151]
    s_waitcnt lgkmcnt(12)
    v_mfma_f32_16x16x32_bf16 v[176:179], v[196:199], v[36:39], v[176:179]
    ds_read_b64 v[224:225], v3 offset:1408
    ds_read_b64 v[226:227], v3 offset:1416
    v_mfma_f32_16x16x32_bf16 v[172:175], v[196:199], v[52:55], v[172:175]
    v_mfma_f32_16x16x32_bf16 v[168:171], v[196:199], v[68:71], v[168:171]
    v_mfma_f32_16x16x32_bf16 v[164:167], v[196:199], v[84:87], v[164:167]
    v_mfma_f32_16x16x32_bf16 v[160:163], v[196:199], v[100:103], v[160:163]
    v_mfma_f32_16x16x32_bf16 v[156:159], v[196:199], v[116:119], v[156:159]
    v_mfma_f32_16x16x32_bf16 v[152:155], v[196:199], v[132:135], v[152:155]
    s_waitcnt lgkmcnt(12)
    v_mfma_f32_16x16x32_bf16 v[176:179], v[200:203], v[40:43], v[176:179]
    ds_read_b64 v[228:229], v3 offset:1536
    ds_read_b64 v[230:231], v3 offset:1544
    v_mfma_f32_16x16x32_bf16 v[172:175], v[200:203], v[56:59], v[172:175]
    s_waitcnt vmcnt(0)
    s_lshl_b32 s4, s48, 3
    s_add_u32 s4, s4, s49
    s_lshl_b32 s4, s4, 7
    s_lshl_b32 s5, s59, 2
    s_add_u32 s4, s4, s5
    s_add_u32 s57, s4, 0xa08000
    v_mov_b32 v4, s57
    v_mov_b32 v5, s51
    s_mov_b64 exec, 1
    buffer_store_dword v5, v4, s[36:39], 0 offen sc1
    s_mov_b64 exec, -1
    v_mfma_f32_16x16x32_bf16 v[168:171], v[200:203], v[72:75], v[168:171]
    v_mfma_f32_16x16x32_bf16 v[164:167], v[200:203], v[88:91], v[164:167]
    v_mfma_f32_16x16x32_bf16 v[160:163], v[200:203], v[104:107], v[160:163]
    v_mfma_f32_16x16x32_bf16 v[156:159], v[200:203], v[120:123], v[156:159]
    v_mfma_f32_16x16x32_bf16 v[152:155], v[200:203], v[136:139], v[152:155]
    s_waitcnt lgkmcnt(12)
    v_mfma_f32_16x16x32_bf16 v[176:179], v[204:207], v[44:47], v[176:179]
    ds_read_b64 v[232:233], v3 offset:1664
    ds_read_b64 v[234:235], v3 offset:1672
    v_mfma_f32_16x16x32_bf16 v[172:175], v[204:207], v[60:63], v[172:175]
    v_mfma_f32_16x16x32_bf16 v[168:171], v[204:207], v[76:79], v[168:171]
    v_mfma_f32_16x16x32_bf16 v[164:167], v[204:207], v[92:95], v[164:167]
    v_mfma_f32_16x16x32_bf16 v[160:163], v[204:207], v[108:111], v[160:163]
    v_mfma_f32_16x16x32_bf16 v[156:159], v[204:207], v[124:127], v[156:159]
    v_mfma_f32_16x16x32_bf16 v[152:155], v[204:207], v[140:143], v[152:155]
    s_waitcnt lgkmcnt(12)
    v_mfma_f32_16x16x32_bf16 v[176:179], v[208:211], v[48:51], v[176:179]
    ds_read_b64 v[236:237], v3 offset:1792
    ds_read_b64 v[238:239], v3 offset:1800
    v_mfma_f32_16x16x32_bf16 v[172:175], v[208:211], v[64:67], v[172:175]
    v_mfma_f32_16x16x32_bf16 v[168:171], v[208:211], v[80:83], v[168:171]
    v_mfma_f32_16x16x32_bf16 v[164:167], v[208:211], v[96:99], v[164:167]
    v_mfma_f32_16x16x32_bf16 v[160:163], v[208:211], v[112:115], v[160:163]
    v_mfma_f32_16x16x32_bf16 v[156:159], v[208:211], v[128:131], v[156:159]
    v_mfma_f32_16x16x32_bf16 v[152:155], v[208:211], v[144:147], v[152:155]
    s_waitcnt lgkmcnt(12)
    v_mfma_f32_16x16x32_bf16 v[176:179], v[212:215], v[52:55], v[176:179]
    ds_read_b64 v[240:241], v3 offset:1920
    ds_read_b64 v[242:243], v3 offset:1928
    v_mfma_f32_16x16x32_bf16 v[172:175], v[212:215], v[68:71], v[172:175]
    v_mfma_f32_16x16x32_bf16 v[168:171], v[212:215], v[84:87], v[168:171]
    v_mfma_f32_16x16x32_bf16 v[164:167], v[212:215], v[100:103], v[164:167]
    v_mfma_f32_16x16x32_bf16 v[160:163], v[212:215], v[116:119], v[160:163]
    v_mfma_f32_16x16x32_bf16 v[156:159], v[212:215], v[132:135], v[156:159]
    s_waitcnt lgkmcnt(12)
    v_mfma_f32_16x16x32_bf16 v[176:179], v[216:219], v[56:59], v[176:179]
    ds_read_b64 v[180:181], v3 offset:2048
    ds_read_b64 v[182:183], v3 offset:2056
    v_mfma_f32_16x16x32_bf16 v[172:175], v[216:219], v[72:75], v[172:175]
    v_mfma_f32_16x16x32_bf16 v[168:171], v[216:219], v[88:91], v[168:171]
    v_mfma_f32_16x16x32_bf16 v[164:167], v[216:219], v[104:107], v[164:167]
    v_mfma_f32_16x16x32_bf16 v[160:163], v[216:219], v[120:123], v[160:163]
    v_mfma_f32_16x16x32_bf16 v[156:159], v[216:219], v[136:139], v[156:159]
    s_waitcnt lgkmcnt(12)
    v_mfma_f32_16x16x32_bf16 v[176:179], v[220:223], v[60:63], v[176:179]
    ds_read_b64 v[184:185], v3 offset:2176
    ds_read_b64 v[186:187], v3 offset:2184
    v_mfma_f32_16x16x32_bf16 v[172:175], v[220:223], v[76:79], v[172:175]
    v_mfma_f32_16x16x32_bf16 v[168:171], v[220:223], v[92:95], v[168:171]
    v_mfma_f32_16x16x32_bf16 v[164:167], v[220:223], v[108:111], v[164:167]
    v_mfma_f32_16x16x32_bf16 v[160:163], v[220:223], v[124:127], v[160:163]
    v_mfma_f32_16x16x32_bf16 v[156:159], v[220:223], v[140:143], v[156:159]
    s_waitcnt lgkmcnt(12)
    v_mfma_f32_16x16x32_bf16 v[176:179], v[224:227], v[64:67], v[176:179]
    ds_read_b64 v[188:189], v3 offset:2304
    ds_read_b64 v[190:191], v3 offset:2312
    v_mfma_f32_16x16x32_bf16 v[172:175], v[224:227], v[80:83], v[172:175]
    v_mfma_f32_16x16x32_bf16 v[168:171], v[224:227], v[96:99], v[168:171]
    v_mfma_f32_16x16x32_bf16 v[164:167], v[224:227], v[112:115], v[164:167]
    v_mfma_f32_16x16x32_bf16 v[160:163], v[224:227], v[128:131], v[160:163]
    v_mfma_f32_16x16x32_bf16 v[156:159], v[224:227], v[144:147], v[156:159]
    s_waitcnt lgkmcnt(12)
    v_mfma_f32_16x16x32_bf16 v[176:179], v[228:231], v[68:71], v[176:179]
    ds_read_b64 v[192:193], v3 offset:2432
    ds_read_b64 v[194:195], v3 offset:2440
    v_mfma_f32_16x16x32_bf16 v[172:175], v[228:231], v[84:87], v[172:175]
    v_mfma_f32_16x16x32_bf16 v[168:171], v[228:231], v[100:103], v[168:171]
    v_mfma_f32_16x16x32_bf16 v[164:167], v[228:231], v[116:119], v[164:167]
    v_mfma_f32_16x16x32_bf16 v[160:163], v[228:231], v[132:135], v[160:163]
    s_waitcnt lgkmcnt(12)
    v_mfma_f32_16x16x32_bf16 v[176:179], v[232:235], v[72:75], v[176:179]
    ds_read_b64 v[196:197], v3 offset:2560
    ds_read_b64 v[198:199], v3 offset:2568
    v_mfma_f32_16x16x32_bf16 v[172:175], v[232:235], v[88:91], v[172:175]
    v_mfma_f32_16x16x32_bf16 v[168:171], v[232:235], v[104:107], v[168:171]
    v_mfma_f32_16x16x32_bf16 v[164:167], v[232:235], v[120:123], v[164:167]
    v_mfma_f32_16x16x32_bf16 v[160:163], v[232:235], v[136:139], v[160:163]
    s_waitcnt lgkmcnt(12)
    v_mfma_f32_16x16x32_bf16 v[176:179], v[236:239], v[76:79], v[176:179]
    ds_read_b64 v[200:201], v3 offset:2688
    ds_read_b64 v[202:203], v3 offset:2696
    v_mfma_f32_16x16x32_bf16 v[172:175], v[236:239], v[92:95], v[172:175]
    v_mfma_f32_16x16x32_bf16 v[168:171], v[236:239], v[108:111], v[168:171]
    v_mfma_f32_16x16x32_bf16 v[164:167], v[236:239], v[124:127], v[164:167]
    v_mfma_f32_16x16x32_bf16 v[160:163], v[236:239], v[140:143], v[160:163]
    s_waitcnt lgkmcnt(12)
    v_mfma_f32_16x16x32_bf16 v[176:179], v[240:243], v[80:83], v[176:179]
    ds_read_b64 v[204:205], v3 offset:2816
    ds_read_b64 v[206:207], v3 offset:2824
    v_mfma_f32_16x16x32_bf16 v[172:175], v[240:243], v[96:99], v[172:175]
    v_mfma_f32_16x16x32_bf16 v[168:171], v[240:243], v[112:115], v[168:171]
    v_mfma_f32_16x16x32_bf16 v[164:167], v[240:243], v[128:131], v[164:167]
    v_mfma_f32_16x16x32_bf16 v[160:163], v[240:243], v[144:147], v[160:163]
    s_waitcnt lgkmcnt(12)
    v_mfma_f32_16x16x32_bf16 v[176:179], v[180:183], v[84:87], v[176:179]
    ds_read_b64 v[208:209], v3 offset:2944
    ds_read_b64 v[210:211], v3 offset:2952
    v_mfma_f32_16x16x32_bf16 v[172:175], v[180:183], v[100:103], v[172:175]
    v_mfma_f32_16x16x32_bf16 v[168:171], v[180:183], v[116:119], v[168:171]
    v_mfma_f32_16x16x32_bf16 v[164:167], v[180:183], v[132:135], v[164:167]
    s_waitcnt lgkmcnt(12)
    v_mfma_f32_16x16x32_bf16 v[176:179], v[184:187], v[88:91], v[176:179]
    ds_read_b64 v[212:213], v3 offset:3072
    ds_read_b64 v[214:215], v3 offset:3080
    v_mfma_f32_16x16x32_bf16 v[172:175], v[184:187], v[104:107], v[172:175]
    v_mfma_f32_16x16x32_bf16 v[168:171], v[184:187], v[120:123], v[168:171]
    v_mfma_f32_16x16x32_bf16 v[164:167], v[184:187], v[136:139], v[164:167]
    s_waitcnt lgkmcnt(12)
    v_mfma_f32_16x16x32_bf16 v[176:179], v[188:191], v[92:95], v[176:179]
    ds_read_b64 v[216:217], v3 offset:3200
    ds_read_b64 v[218:219], v3 offset:3208
    v_mfma_f32_16x16x32_bf16 v[172:175], v[188:191], v[108:111], v[172:175]
    v_mfma_f32_16x16x32_bf16 v[168:171], v[188:191], v[124:127], v[168:171]
    v_mfma_f32_16x16x32_bf16 v[164:167], v[188:191], v[140:143], v[164:167]
    s_waitcnt lgkmcnt(12)
    v_mfma_f32_16x16x32_bf16 v[176:179], v[192:195], v[96:99], v[176:179]
    ds_read_b64 v[220:221], v3 offset:3328
    ds_read_b64 v[222:223], v3 offset:3336
    v_mfma_f32_16x16x32_bf16 v[172:175], v[192:195], v[112:115], v[172:175]
    v_mfma_f32_16x16x32_bf16 v[168:171], v[192:195], v[128:131], v[168:171]
    v_mfma_f32_16x16x32_bf16 v[164:167], v[192:195], v[144:147], v[164:167]
    s_waitcnt lgkmcnt(10)
    v_mfma_f32_16x16x32_bf16 v[176:179], v[196:199], v[100:103], v[176:179]
    ds_read_b64 v[224:225], v3 offset:3456
    ds_read_b64 v[226:227], v3 offset:3464
    v_mfma_f32_16x16x32_bf16 v[172:175], v[196:199], v[116:119], v[172:175]
    ds_read_b64 v[228:229], v3 offset:3584
    ds_read_b64 v[230:231], v3 offset:3592
    v_mfma_f32_16x16x32_bf16 v[168:171], v[196:199], v[132:135], v[168:171]
    v_mfma_f32_16x16x32_bf16 v[176:179], v[200:203], v[104:107], v[176:179]
    v_mfma_f32_16x16x32_bf16 v[172:175], v[200:203], v[120:123], v[172:175]
    v_mfma_f32_16x16x32_bf16 v[168:171], v[200:203], v[136:139], v[168:171]
    s_waitcnt lgkmcnt(10)
    v_mfma_f32_16x16x32_bf16 v[176:179], v[204:207], v[108:111], v[176:179]
    ds_read_b64 v[232:233], v3 offset:3712
    ds_read_b64 v[234:235], v3 offset:3720
    v_mfma_f32_16x16x32_bf16 v[172:175], v[204:207], v[124:127], v[172:175]
    ds_read_b64 v[236:237], v3 offset:3840
    ds_read_b64 v[238:239], v3 offset:3848
    v_mfma_f32_16x16x32_bf16 v[168:171], v[204:207], v[140:143], v[168:171]
    v_mfma_f32_16x16x32_bf16 v[176:179], v[208:211], v[112:115], v[176:179]
    v_mfma_f32_16x16x32_bf16 v[172:175], v[208:211], v[128:131], v[172:175]
    v_mfma_f32_16x16x32_bf16 v[168:171], v[208:211], v[144:147], v[168:171]
    s_waitcnt lgkmcnt(10)
    v_mfma_f32_16x16x32_bf16 v[176:179], v[212:215], v[116:119], v[176:179]
    ds_read_b64 v[240:241], v3 offset:3968
    ds_read_b64 v[242:243], v3 offset:3976
    v_mfma_f32_16x16x32_bf16 v[172:175], v[212:215], v[132:135], v[172:175]
    v_mfma_f32_16x16x32_bf16 v[176:179], v[216:219], v[120:123], v[176:179]
    v_mfma_f32_16x16x32_bf16 v[172:175], v[216:219], v[136:139], v[172:175]
    s_waitcnt lgkmcnt(8)
    v_mfma_f32_16x16x32_bf16 v[176:179], v[220:223], v[124:127], v[176:179]
    v_mfma_f32_16x16x32_bf16 v[172:175], v[220:223], v[140:143], v[172:175]
    v_mfma_f32_16x16x32_bf16 v[176:179], v[224:227], v[128:131], v[176:179]
    v_mfma_f32_16x16x32_bf16 v[172:175], v[224:227], v[144:147], v[172:175]
    s_waitcnt lgkmcnt(0)
    v_mfma_f32_16x16x32_bf16 v[176:179], v[228:231], v[132:135], v[176:179]
    v_mfma_f32_16x16x32_bf16 v[176:179], v[232:235], v[136:139], v[176:179]
    v_mfma_f32_16x16x32_bf16 v[176:179], v[236:239], v[140:143], v[176:179]
    v_mfma_f32_16x16x32_bf16 v[176:179], v[240:243], v[144:147], v[176:179]
    s_lshl_b32 s4, s59, 2
    s_add_u32 s4, s4, 162304
    s_xor_b32 s5, s4, 4
    v_mov_b32 v16, s4
    v_mov_b32 v17, 1
    s_waitcnt lgkmcnt(0)
    ds_write_b32 v16, v17
    v_mov_b32 v16, s5
    s_mov_b32 s58, 0
L_ps_5:
    ds_read_b32 v17, v16
    s_waitcnt lgkmcnt(0)
    v_readfirstlane_b32 s4, v17
    s_add_u32 s58, s58, 1
    s_cmp_ge_u32 s4, 1
    s_cbranch_scc1 L_psd_6
    s_cmp_lt_u32 s58, 1000000
    s_cbranch_scc1 L_ps_5
L_psd_6:
    v_lshlrev_b32 v4, 4, v1
    s_mul_i32 s55, s55, 16640
    s_add_u32 s55, s55, 106512
    s_lshl_b32 s57, s56, 12
    s_add_u32 s57, s57, s55
    v_add_u32 v5, s57, v4
    s_xor_b32 s57, s56, 1
    s_lshl_b32 s57, s57, 12
    s_add_u32 s57, s57, s55
    v_add_u32 v6, s57, v4
    s_cmp_eq_u32 s56, 0
    s_cbranch_scc1 L_cr0_7
    ds_write_b128 v5, v[148:151] offset:0
    ds_write_b128 v5, v[152:155] offset:1024
    ds_write_b128 v5, v[156:159] offset:2048
    ds_write_b128 v5, v[160:163] offset:3072
    v_mov_b32 v200, v164
    v_mov_b32 v201, v165
    v_mov_b32 v202, v166
    v_mov_b32 v203, v167
    v_mov_b32 v204, v168
    v_mov_b32 v205, v169
    v_mov_b32 v206, v170
    v_mov_b32 v207, v171
    v_mov_b32 v208, v172
    v_mov_b32 v209, v173
    v_mov_b32 v210, v174
    v_mov_b32 v211, v175
    v_mov_b32 v212, v176
    v_mov_b32 v213, v177
    v_mov_b32 v214, v178
    v_mov_b32 v215, v179
    s_branch L_cr1_8
L_cr0_7:
    ds_write_b128 v5, v[164:167] offset:0
    ds_write_b128 v5, v[168:171] offset:1024
    ds_write_b128 v5, v[172:175] offset:2048
    ds_write_b128 v5, v[176:179] offset:3072
    v_mov_b32 v200, v148
    v_mov_b32 v201, v149
    v_mov_b32 v202, v150
    v_mov_b32 v203, v151
    v_mov_b32 v204, v152
    v_mov_b32 v205, v153
    v_mov_b32 v206, v154
    v_mov_b32 v207, v155
    v_mov_b32 v208, v156
    v_mov_b32 v209, v157
    v_mov_b32 v210, v158
    v_mov_b32 v211, v159
    v_mov_b32 v212, v160
    v_mov_b32 v213, v161
    v_mov_b32 v214, v162
    v_mov_b32 v215, v163
L_cr1_8:
    v_and_b32 v4, 15, v1
    v_lshrrev_b32 v7, 4, v1
    v_lshlrev_b32 v4, 5, v4
    v_lshl_add_u32 v4, v7, 3, v4
    s_lshr_b32 s55, s59, 1
    s_mul_i32 s57, s55, 4608
    s_add_u32 s57, s57, 142456
    s_lshl_b32 s4, s56, 11
    s_sub_u32 s57, s57, s4
    v_sub_u32 v4, s57, v4
    ds_read_b64 v[236:237], v4 offset:1536
    ds_read_b64 v[238:239], v4 offset:1024
    ds_read_b64 v[240:241], v4 offset:512
    ds_read_b64 v[242:243], v4 offset:0
    s_and_b32 s4, s66, 0xffff
    s_lshr_b32 s5, s66, 16
    s_cmp_eq_u32 s55, 0
    s_cselect_b32 s4, s4, s5
    s_lshl_b32 s5, s4, 16
    v_mov_b32 v8, s4
    v_mov_b32 v9, s5
    s_lshl_b32 s4, s59, 2
    s_add_u32 s4, s4, 162320
    s_xor_b32 s5, s4, 4
    v_mov_b32 v16, s4
    v_mov_b32 v17, 1
    s_waitcnt lgkmcnt(0)
    ds_write_b32 v16, v17
    v_mov_b32 v16, s5
    s_mov_b32 s58, 0
L_ps_9:
    ds_read_b32 v17, v16
    s_waitcnt lgkmcnt(0)
    v_readfirstlane_b32 s4, v17
    s_add_u32 s58, s58, 1
    s_cmp_ge_u32 s4, 1
    s_cbranch_scc1 L_psd_10
    s_cmp_lt_u32 s58, 1000000
    s_cbranch_scc1 L_ps_9
L_psd_10:
    ds_read_b128 v[220:223], v6 offset:0
    ds_read_b128 v[224:227], v6 offset:1024
    ds_read_b128 v[228:231], v6 offset:2048
    ds_read_b128 v[232:235], v6 offset:3072
    v_dot2_f32_bf16 v148, v237, v9, 0
    v_dot2_f32_bf16 v149, v237, v8, 0
    v_dot2_f32_bf16 v150, v236, v9, 0
    v_dot2_f32_bf16 v151, v236, v8, 0
    v_dot2_f32_bf16 v152, v239, v9, 0
    v_dot2_f32_bf16 v153, v239, v8, 0
    v_dot2_f32_bf16 v154, v238, v9, 0
    v_dot2_f32_bf16 v155, v238, v8, 0
    v_dot2_f32_bf16 v156, v241, v9, 0
    v_dot2_f32_bf16 v157, v241, v8, 0
    v_dot2_f32_bf16 v158, v240, v9, 0
    v_dot2_f32_bf16 v159, v240, v8, 0
    v_dot2_f32_bf16 v160, v243, v9, 0
    v_dot2_f32_bf16 v161, v243, v8, 0
    v_dot2_f32_bf16 v162, v242, v9, 0
    v_dot2_f32_bf16 v163, v242, v8, 0
    v_cvt_pk_bf16_f32 v164, v148, v149
    v_cvt_pk_bf16_f32 v165, v150, v151
    v_cvt_pk_bf16_f32 v166, v152, v153
    v_cvt_pk_bf16_f32 v167, v154, v155
    v_cvt_pk_bf16_f32 v168, v156, v157
    v_cvt_pk_bf16_f32 v169, v158, v159
    v_cvt_pk_bf16_f32 v170, v160, v161
    v_cvt_pk_bf16_f32 v171, v162, v163
    v_and_b32 v4, 15, v1
    v_lshrrev_b32 v5, 2, v4
    v_lshlrev_b32 v5, 16, v5
    v_and_b32 v4, 3, v4
    v_lshl_add_u32 v5, v4, 5, v5
    v_lshrrev_b32 v7, 4, v1
    v_lshl_add_u32 v5, v7, 3, v5
    s_lshl_b32 s57, s49, 6
    s_lshl_b32 s4, s48, 1
    s_add_u32 s57, s57, s4
    s_add_u32 s57, s57, s55
    s_lshl_b32 s57, s57, 7
    s_lshl_b32 s4, s56, 20
    s_add_u32 s57, s57, s4
    s_add_u32 s57, s57, 0x200000
    v_add_u32 v5, s57, v5
    s_waitcnt lgkmcnt(0)
    v_add_f32 v200, v200, v220
    v_add_f32 v201, v201, v221
    v_add_f32 v202, v202, v222
    v_add_f32 v203, v203, v223
    v_add_f32 v204, v204, v224
    v_add_f32 v205, v205, v225
    v_add_f32 v206, v206, v226
    v_add_f32 v207, v207, v227
    v_add_f32 v208, v208, v228
    v_add_f32 v209, v209, v229
    v_add_f32 v210, v210, v230
    v_add_f32 v211, v211, v231
    v_add_f32 v212, v212, v232
    v_add_f32 v213, v213, v233
    v_add_f32 v214, v214, v234
    v_add_f32 v215, v215, v235
    v_cvt_pk_bf16_f32 v172, v200, v201
    v_cvt_pk_bf16_f32 v173, v202, v203
    v_cvt_pk_bf16_f32 v174, v204, v205
    v_cvt_pk_bf16_f32 v175, v206, v207
    v_cvt_pk_bf16_f32 v176, v208, v209
    v_cvt_pk_bf16_f32 v177, v210, v211
    v_cvt_pk_bf16_f32 v178, v212, v213
    v_cvt_pk_bf16_f32 v179, v214, v215
    v_perm_b32 v200, v164, v172, s68
    v_perm_b32 v201, v164, v172, s69
    v_perm_b32 v202, v165, v173, s68
    v_perm_b32 v203, v165, v173, s69
    v_perm_b32 v204, v166, v174, s68
    v_perm_b32 v205, v166, v174, s69
    v_perm_b32 v206, v167, v175, s68
    v_perm_b32 v207, v167, v175, s69
    v_perm_b32 v208, v168, v176, s68
    v_perm_b32 v209, v168, v176, s69
    v_perm_b32 v210, v169, v177, s68
    v_perm_b32 v211, v169, v177, s69
    v_perm_b32 v212, v170, v178, s68
    v_perm_b32 v213, v170, v178, s69
    v_perm_b32 v214, v171, v179, s68
    v_perm_b32 v215, v171, v179, s69
    v_dot2_f32_bf16 v220, v200, v252, 0
    v_dot2_f32_bf16 v221, v201, v252, 0
    v_dot2_f32_bf16 v222, v202, v252, 0
    v_dot2_f32_bf16 v223, v203, v252, 0
    v_dot2_f32_bf16 v224, v204, v252, 0
    v_dot2_f32_bf16 v225, v205, v252, 0
    v_dot2_f32_bf16 v226, v206, v252, 0
    v_dot2_f32_bf16 v227, v207, v252, 0
    v_dot2_f32_bf16 v228, v208, v252, 0
    v_dot2_f32_bf16 v229, v209, v252, 0
    v_dot2_f32_bf16 v230, v210, v252, 0
    v_dot2_f32_bf16 v231, v211, v252, 0
    v_dot2_f32_bf16 v232, v212, v252, 0
    v_dot2_f32_bf16 v233, v213, v252, 0
    v_dot2_f32_bf16 v234, v214, v252, 0
    v_dot2_f32_bf16 v235, v215, v252, 0
    v_cvt_pk_bf16_f32 v180, v220, v221
    v_cvt_pk_bf16_f32 v181, v222, v223
    v_cvt_pk_bf16_f32 v182, v224, v225
    v_cvt_pk_bf16_f32 v183, v226, v227
    v_cvt_pk_bf16_f32 v184, v228, v229
    v_cvt_pk_bf16_f32 v185, v230, v231
    v_cvt_pk_bf16_f32 v186, v232, v233
    v_cvt_pk_bf16_f32 v187, v234, v235
    buffer_store_dwordx2 v[180:181], v5, s[36:39], 0 offen sc1
    v_add_u32 v5, 0x40000, v5
    buffer_store_dwordx2 v[182:183], v5, s[36:39], 0 offen sc1
    v_add_u32 v5, 0x40000, v5
    buffer_store_dwordx2 v[184:185], v5, s[36:39], 0 offen sc1
    v_add_u32 v5, 0x40000, v5
    buffer_store_dwordx2 v[186:187], v5, s[36:39], 0 offen sc1
    v_lshrrev_b32 v2, 3, v1
    v_and_b32 v2, 3, v2
    v_lshrrev_b32 v3, 5, v1
    v_lshl_add_u32 v2, v3, 3, v2
    v_lshlrev_b32 v2, 10, v2
    v_lshrrev_b32 v3, 4, v1
    v_and_b32 v3, 3, v3
    v_lshlrev_b32 v3, 1, v3
    v_and_b32 v4, 7, v1
    v_xor_b32 v3, v3, v4
    v_lshl_add_u32 v2, v3, 4, v2
    s_lshl_b32 s55, s85, 7
    v_add_u32 v14, s55, v2
    s_lshr_b32 s75, s59, 1
    s_and_b32 s76, s59, 1
    s_mul_i32 s70, s75, 720896
    v_mov_b32 v16, 162352
    v_mov_b32 v17, 1
    s_waitcnt lgkmcnt(0)
    s_mov_b64 exec, 1
    ds_add_u32 v16, v17
    s_mov_b64 exec, -1
    s_mov_b32 s5, 162352
    v_mov_b32 v16, s5
    s_mov_b32 s58, 0
L_ps_11:
    ds_read_b32 v17, v16
    s_waitcnt lgkmcnt(0)
    v_readfirstlane_b32 s4, v17
    s_add_u32 s58, s58, 1
    s_cmp_ge_u32 s4, 4
    s_cbranch_scc1 L_psd_12
    s_cmp_lt_u32 s58, 1000000
    s_cbranch_scc1 L_ps_11
L_psd_12:
    s_mul_i32 s71, s75, 24576
    s_add_u32 s71, s71, 106496
    s_lshl_b32 s4, s76, 12
    s_add_u32 s71, s71, s4
    s_lshl_b32 s4, s76, 15
    s_add_u32 s70, s70, s4
    s_add_u32 s57, s70, 425984
    s_add_u32 m0, s71, 0
    s_nop 0
    buffer_load_dwordx4 v14, s[24:27], s57 offen lds
    s_add_u32 m0, s71, 1024
    s_add_u32 s57, s57, 4096
    buffer_load_dwordx4 v14, s[24:27], s57 offen lds
    s_add_u32 m0, s71, 2048
    s_add_u32 s57, s57, 12288
    buffer_load_dwordx4 v14, s[24:27], s57 offen lds
    s_add_u32 m0, s71, 3072
    s_add_u32 s57, s57, 4096
    buffer_load_dwordx4 v14, s[24:27], s57 offen lds
    s_add_u32 s57, s70, 491520
    s_add_u32 m0, s71, 8192
    s_nop 0
    buffer_load_dwordx4 v14, s[24:27], s57 offen lds
    s_add_u32 m0, s71, 9216
    s_add_u32 s57, s57, 4096
    buffer_load_dwordx4 v14, s[24:27], s57 offen lds
    s_add_u32 m0, s71, 10240
    s_add_u32 s57, s57, 12288
    buffer_load_dwordx4 v14, s[24:27], s57 offen lds
    s_add_u32 m0, s71, 11264
    s_add_u32 s57, s57, 4096
    buffer_load_dwordx4 v14, s[24:27], s57 offen lds
    s_add_u32 s57, s70, 557056
    s_add_u32 m0, s71, 16384
    s_nop 0
    buffer_load_dwordx4 v14, s[24:27], s57 offen lds
    s_add_u32 m0, s71, 17408
    s_add_u32 s57, s57, 4096
    buffer_load_dwordx4 v14, s[24:27], s57 offen lds
    s_add_u32 m0, s71, 18432
    s_add_u32 s57, s57, 12288
    buffer_load_dwordx4 v14, s[24:27], s57 offen lds
    s_add_u32 m0, s71, 19456
    s_add_u32 s57, s57, 4096
    buffer_load_dwordx4 v14, s[24:27], s57 offen lds
    s_waitcnt vmcnt(12)
    s_lshl_b32 s4, s81, 7
    s_lshl_b32 s5, s59, 2
    s_add_u32 s4, s4, s5
    s_add_u32 s57, s4, 0xa10000
    v_mov_b32 v2, s57
    v_mov_b32 v3, s51
    s_mov_b64 exec, 1
    buffer_store_dword v3, v2, s[36:39], 0 offen sc1
    s_mov_b64 exec, -1
    s_mov_b32 s5, 162360
    v_mov_b32 v16, s5
    s_mov_b32 s58, 0
L_ps_13:
    ds_read_b32 v17, v16
    s_waitcnt lgkmcnt(0)
    v_readfirstlane_b32 s4, v17
    s_add_u32 s58, s58, 1
    s_cmp_ge_u32 s4, 4
    s_cbranch_scc1 L_psd_14
    s_cmp_lt_u32 s58, 1000000
    s_cbranch_scc1 L_ps_13
L_psd_14:
    s_mul_i32 s71, s75, 53248
    s_lshl_b32 s4, s76, 12
    s_add_u32 s71, s71, s4
    s_add_u32 s57, s70, 622592
    s_add_u32 m0, s71, 0
    s_nop 0
    buffer_load_dwordx4 v14, s[24:27], s57 offen lds
    s_add_u32 m0, s71, 1024
    s_add_u32 s57, s57, 4096
    buffer_load_dwordx4 v14, s[24:27], s57 offen lds
    s_add_u32 m0, s71, 2048
    s_add_u32 s57, s57, 12288
    buffer_load_dwordx4 v14, s[24:27], s57 offen lds
    s_add_u32 m0, s71, 3072
    s_add_u32 s57, s57, 4096
    buffer_load_dwordx4 v14, s[24:27], s57 offen lds
    s_cmp_eq_u32 s76, 1
    s_cbranch_scc1 L_ml_15
    s_add_u32 s57, s70, 688128
    s_add_u32 m0, s71, 8192
    s_nop 0
    buffer_load_dwordx4 v14, s[24:27], s57 offen lds
    s_add_u32 m0, s71, 9216
    s_add_u32 s57, s57, 4096
    buffer_load_dwordx4 v14, s[24:27], s57 offen lds
    s_add_u32 m0, s71, 10240
    s_add_u32 s57, s57, 12288
    buffer_load_dwordx4 v14, s[24:27], s57 offen lds
    s_add_u32 m0, s71, 11264
    s_add_u32 s57, s57, 4096
    buffer_load_dwordx4 v14, s[24:27], s57 offen lds
L_ml_15:
    s_and_b32 s55, s50, 3
    s_lshl_b32 s55, s55, 4
    s_lshl_b32 s56, s48, 6
    s_add_u32 s55, s55, s56
    s_lshl_b32 s55, s55, 10
    s_lshl_b32 s56, s85, 7
    s_add_u32 s55, s55, s56
    s_lshr_b32 s56, s50, 2
    s_lshl_b32 s56, s56, 6
    s_add_u32 s55, s55, s56
    v_lshrrev_b32 v2, 2, v1
    v_lshlrev_b32 v2, 10, v2
    v_and_b32 v3, 3, v1
    v_lshl_add_u32 v2, v3, 4, v2
    v_add_u32 v96, s55, v2
    buffer_load_dwordx4 v[84:87], v96, s[8:11], 0 offen
    v_lshrrev_b32 v3, 2, v0
    v_and_b32 v4, 3, v0
    v_lshlrev_b32 v5, 7, v3
    v_lshl_add_u32 v5, v4, 5, v5
    s_lshl_b32 s55, s48, 16
    s_lshl_b32 s56, s85, 13
    s_add_u32 s55, s55, s56
    s_add_u32 s55, s55, 0x200000
    v_add_u32 v8, s55, v5
    v_mul_u32_u24 v9, 144, v3
    v_lshl_add_u32 v9, v4, 5, v9
    v_add_u32 v9, 16384, v9
    s_waitcnt vmcnt(6)
    s_barrier
    s_waitcnt vmcnt(0)
    s_barrier
    s_lshl_b32 s55, s85, 12
    s_add_u32 s55, s55, 0xa10000
    v_mul_u32_u24 v2, 128, v1
    v_add_u32 v2, s55, v2
    s_mov_b32 s58, 0
    s_mov_b32 exec_lo, -1
    s_mov_b32 exec_hi, 0
L_poll_16:
    buffer_load_dwordx4 v[4:7], v2, s[36:39], 0 offen sc1
    s_waitcnt vmcnt(0)
    v_xor_b32 v4, s51, v4
    v_xor_b32 v5, s51, v5
    v_xor_b32 v6, s51, v6
    v_xor_b32 v7, s51, v7
    v_or3_b32 v4, v4, v5, v6
    v_or_b32 v4, v4, v7
    v_cmp_ne_u32 vcc, 0, v4
    s_add_u32 s58, s58, 1
    s_cmp_gt_u32 s58, 100000
    s_cbranch_scc1 L_pdone_17
    s_cbranch_vccnz L_poll_16
L_pdone_17:
    s_mov_b64 exec, -1
    buffer_load_dwordx4 v[20:23], v8, s[36:39], 0 offen sc1
    buffer_load_dwordx4 v[24:27], v8, s[36:39], 0 offen offset:16 sc1
    s_waitcnt vmcnt(0)
    ds_write_b128 v9, v[20:23]
    ds_write_b128 v9, v[24:27] offset:16
    s_waitcnt lgkmcnt(0)
    s_barrier
    s_branch L_final
L_H:
    s_load_dwordx2 s[20:21], s[0:1], 56
    s_load_dwordx2 s[32:33], s[0:1], 32
    s_load_dwordx2 s[36:37], s[0:1], 88
    s_load_dwordx2 s[44:45], s[0:1], 80
    s_load_dwordx2 s[24:25], s[0:1], 64
    s_load_dwordx2 s[28:29], s[0:1], 72
    s_load_dwordx2 s[64:65], s[0:1], 40
    s_mov_b32 s22, 0x158000
    s_mov_b32 s23, 0x00020000
    s_mov_b32 s34, 0x200000
    s_mov_b32 s35, 0x00020000
    s_mov_b32 s38, 0x1000000
    s_mov_b32 s39, 0x00020000
    s_mov_b32 s46, 0x100
    s_mov_b32 s47, 0x00020000
    s_mov_b32 s26, 0x158000
    s_mov_b32 s27, 0x00020000
    s_mov_b32 s30, 0x200000
    s_mov_b32 s31, 0x00020000
    s_mov_b32 s85, s49
    s_lshl_b32 s81, s49, 5
    s_add_u32 s81, s81, s48
    s_mul_i32 s53, s49, 6
    s_sub_i32 s55, s49, 3
    s_max_i32 s55, s55, 0
    s_sub_u32 s53, s53, s55
    s_lshl_b32 s52, s53, 5
    s_cmp_lt_u32 s49, 3
    s_cselect_b32 s54, 12, 10
    v_mov_b32 v248, 0xffff
    v_mov_b32 v249, 0xffff0000
    v_mov_b32 v250, 0x3f80
    v_mov_b32 v251, 0x3f800000
    v_mov_b32 v252, 0x3f803f80
    s_mov_b32 s68, 0x05040100
    s_mov_b32 s69, 0x07060302
    v_and_b32 v3, 15, v0
    v_lshlrev_b32 v3, 2, v3
    v_add_u32 v3, 162304, v3
    v_mov_b32 v4, 0
    ds_write_b32 v3, v4
    s_waitcnt lgkmcnt(0)
    s_waitcnt lgkmcnt(0)
    s_barrier
    s_setprio 0
    v_mov_b32 v7, 0
    v_lshrrev_b32 v4, 2, v1
    v_and_b32 v5, 3, v1
    v_lshlrev_b32 v2, 1, v5
    v_xor_b32 v4, v4, v2
    v_lshlrev_b32 v4, 4, v4
    v_lshl_add_u32 v4, v5, 8, v4
    s_lshl_b32 s57, s59, 11
    v_add_u32 v116, s57, v4
    v_mov_b32 v104, 0
    v_mov_b32 v105, 0
    v_mov_b32 v106, 0
    v_mov_b32 v107, 0
    v_mov_b32 v108, 0
    v_mov_b32 v109, 0
    v_mov_b32 v110, 0
    v_mov_b32 v111, 0
    s_waitcnt vmcnt(14)
    v_dot2_f32_bf16 v104, v20, v252, v104
    v_dot2_f32_bf16 v108, v20, v20, v108
    v_dot2_f32_bf16 v105, v21, v252, v105
    v_dot2_f32_bf16 v109, v21, v21, v109
    v_dot2_f32_bf16 v106, v22, v252, v106
    v_dot2_f32_bf16 v110, v22, v22, v110
    v_dot2_f32_bf16 v107, v23, v252, v107
    v_dot2_f32_bf16 v111, v23, v23, v111
    v_dot2_f32_bf16 v104, v24, v252, v104
    v_dot2_f32_bf16 v108, v24, v24, v108
    v_dot2_f32_bf16 v105, v25, v252, v105
    v_dot2_f32_bf16 v109, v25, v25, v109
    v_dot2_f32_bf16 v106, v26, v252, v106
    v_dot2_f32_bf16 v110, v26, v26, v110
    v_dot2_f32_bf16 v107, v27, v252, v107
    v_dot2_f32_bf16 v111, v27, v27, v111
    s_waitcnt vmcnt(12)
    v_dot2_f32_bf16 v104, v28, v252, v104
    v_dot2_f32_bf16 v108, v28, v28, v108
    v_dot2_f32_bf16 v105, v29, v252, v105
    v_dot2_f32_bf16 v109, v29, v29, v109
    v_dot2_f32_bf16 v106, v30, v252, v106
    v_dot2_f32_bf16 v110, v30, v30, v110
    v_dot2_f32_bf16 v107, v31, v252, v107
    v_dot2_f32_bf16 v111, v31, v31, v111
    v_dot2_f32_bf16 v104, v32, v252, v104
    v_dot2_f32_bf16 v108, v32, v32, v108
    v_dot2_f32_bf16 v105, v33, v252, v105
    v_dot2_f32_bf16 v109, v33, v33, v109
    v_dot2_f32_bf16 v106, v34, v252, v106
    v_dot2_f32_bf16 v110, v34, v34, v110
    v_dot2_f32_bf16 v107, v35, v252, v107
    v_dot2_f32_bf16 v111, v35, v35, v111
    s_waitcnt vmcnt(10)
    v_dot2_f32_bf16 v104, v36, v252, v104
    v_dot2_f32_bf16 v108, v36, v36, v108
    v_dot2_f32_bf16 v105, v37, v252, v105
    v_dot2_f32_bf16 v109, v37, v37, v109
    v_dot2_f32_bf16 v106, v38, v252, v106
    v_dot2_f32_bf16 v110, v38, v38, v110
    v_dot2_f32_bf16 v107, v39, v252, v107
    v_dot2_f32_bf16 v111, v39, v39, v111
    v_dot2_f32_bf16 v104, v40, v252, v104
    v_dot2_f32_bf16 v108, v40, v40, v108
    v_dot2_f32_bf16 v105, v41, v252, v105
    v_dot2_f32_bf16 v109, v41, v41, v109
    v_dot2_f32_bf16 v106, v42, v252, v106
    v_dot2_f32_bf16 v110, v42, v42, v110
    v_dot2_f32_bf16 v107, v43, v252, v107
    v_dot2_f32_bf16 v111, v43, v43, v111
    s_waitcnt vmcnt(8)
    v_dot2_f32_bf16 v104, v44, v252, v104
    v_dot2_f32_bf16 v108, v44, v44, v108
    v_dot2_f32_bf16 v105, v45, v252, v105
    v_dot2_f32_bf16 v109, v45, v45, v109
    v_dot2_f32_bf16 v106, v46, v252, v106
    v_dot2_f32_bf16 v110, v46, v46, v110
    v_dot2_f32_bf16 v107, v47, v252, v107
    v_dot2_f32_bf16 v111, v47, v47, v111
    v_dot2_f32_bf16 v104, v48, v252, v104
    v_dot2_f32_bf16 v108, v48, v48, v108
    v_dot2_f32_bf16 v105, v49, v252, v105
    v_dot2_f32_bf16 v109, v49, v49, v109
    v_dot2_f32_bf16 v106, v50, v252, v106
    v_dot2_f32_bf16 v110, v50, v50, v110
    v_dot2_f32_bf16 v107, v51, v252, v107
    v_dot2_f32_bf16 v111, v51, v51, v111
    s_waitcnt vmcnt(6)
    v_dot2_f32_bf16 v104, v52, v252, v104
    v_dot2_f32_bf16 v108, v52, v52, v108
    v_dot2_f32_bf16 v105, v53, v252, v105
    v_dot2_f32_bf16 v109, v53, v53, v109
    v_dot2_f32_bf16 v106, v54, v252, v106
    v_dot2_f32_bf16 v110, v54, v54, v110
    v_dot2_f32_bf16 v107, v55, v252, v107
    v_dot2_f32_bf16 v111, v55, v55, v111
    v_dot2_f32_bf16 v104, v56, v252, v104
    v_dot2_f32_bf16 v108, v56, v56, v108
    v_dot2_f32_bf16 v105, v57, v252, v105
    v_dot2_f32_bf16 v109, v57, v57, v109
    v_dot2_f32_bf16 v106, v58, v252, v106
    v_dot2_f32_bf16 v110, v58, v58, v110
    v_dot2_f32_bf16 v107, v59, v252, v107
    v_dot2_f32_bf16 v111, v59, v59, v111
    s_waitcnt vmcnt(4)
    v_dot2_f32_bf16 v104, v60, v252, v104
    v_dot2_f32_bf16 v108, v60, v60, v108
    v_dot2_f32_bf16 v105, v61, v252, v105
    v_dot2_f32_bf16 v109, v61, v61, v109
    v_dot2_f32_bf16 v106, v62, v252, v106
    v_dot2_f32_bf16 v110, v62, v62, v110
    v_dot2_f32_bf16 v107, v63, v252, v107
    v_dot2_f32_bf16 v111, v63, v63, v111
    v_dot2_f32_bf16 v104, v64, v252, v104
    v_dot2_f32_bf16 v108, v64, v64, v108
    v_dot2_f32_bf16 v105, v65, v252, v105
    v_dot2_f32_bf16 v109, v65, v65, v109
    v_dot2_f32_bf16 v106, v66, v252, v106
    v_dot2_f32_bf16 v110, v66, v66, v110
    v_dot2_f32_bf16 v107, v67, v252, v107
    v_dot2_f32_bf16 v111, v67, v67, v111
    s_waitcnt vmcnt(2)
    v_dot2_f32_bf16 v104, v68, v252, v104
    v_dot2_f32_bf16 v108, v68, v68, v108
    v_dot2_f32_bf16 v105, v69, v252, v105
    v_dot2_f32_bf16 v109, v69, v69, v109
    v_dot2_f32_bf16 v106, v70, v252, v106
    v_dot2_f32_bf16 v110, v70, v70, v110
    v_dot2_f32_bf16 v107, v71, v252, v107
    v_dot2_f32_bf16 v111, v71, v71, v111
    v_dot2_f32_bf16 v104, v72, v252, v104
    v_dot2_f32_bf16 v108, v72, v72, v108
    v_dot2_f32_bf16 v105, v73, v252, v105
    v_dot2_f32_bf16 v109, v73, v73, v109
    v_dot2_f32_bf16 v106, v74, v252, v106
    v_dot2_f32_bf16 v110, v74, v74, v110
    v_dot2_f32_bf16 v107, v75, v252, v107
    v_dot2_f32_bf16 v111, v75, v75, v111
    s_waitcnt vmcnt(0)
    v_dot2_f32_bf16 v104, v76, v252, v104
    v_dot2_f32_bf16 v108, v76, v76, v108
    v_dot2_f32_bf16 v105, v77, v252, v105
    v_dot2_f32_bf16 v109, v77, v77, v109
    v_dot2_f32_bf16 v106, v78, v252, v106
    v_dot2_f32_bf16 v110, v78, v78, v110
    v_dot2_f32_bf16 v107, v79, v252, v107
    v_dot2_f32_bf16 v111, v79, v79, v111
    v_dot2_f32_bf16 v104, v80, v252, v104
    v_dot2_f32_bf16 v108, v80, v80, v108
    v_dot2_f32_bf16 v105, v81, v252, v105
    v_dot2_f32_bf16 v109, v81, v81, v109
    v_dot2_f32_bf16 v106, v82, v252, v106
    v_dot2_f32_bf16 v110, v82, v82, v110
    v_dot2_f32_bf16 v107, v83, v252, v107
    v_dot2_f32_bf16 v111, v83, v83, v111
    v_add_f32 v104, v104, v105
    s_nop 0
    v_add_f32 v106, v106, v107
    v_add_f32 v108, v108, v109
    v_add_f32 v110, v110, v111
    v_add_f32 v2, v104, v106
    v_add_f32 v3, v108, v110
    s_nop 0
    v_add_f32_dpp v2, v2, v2 quad_perm:[1,0,3,2] row_mask:0xf bank_mask:0xf
    v_add_f32_dpp v3, v3, v3 quad_perm:[1,0,3,2] row_mask:0xf bank_mask:0xf
    s_nop 0
    v_add_f32_dpp v2, v2, v2 quad_perm:[2,3,0,1] row_mask:0xf bank_mask:0xf
    v_add_f32_dpp v3, v3, v3 quad_perm:[2,3,0,1] row_mask:0xf bank_mask:0xf
    v_mul_f32 v2, 0x3b000000, v2
    v_mul_f32 v3, 0x3b000000, v3
    v_cvt_pk_bf16_f32 v4, v2, v2
    v_fma_f32 v3, -v2, v2, v3
    v_lshlrev_b32 v4, 16, v4
    v_max_f32 v3, 0, v3
    v_cvt_pk_bf16_f32 v3, v3, v3
    v_lshlrev_b32 v3, 16, v3
    v_add_f32 v3, 0x3727c5ac, v3
    v_cvt_pk_bf16_f32 v3, v3, v3
    v_lshlrev_b32 v3, 16, v3
    v_sqrt_f32 v3, v3
    s_nop 0
    v_cvt_pk_bf16_f32 v3, v3, v3
    v_lshlrev_b32 v3, 16, v3
    v_rcp_f32 v101, v3
    v_sub_f32 v100, 0, v4
    v_mul_f32 v102, v100, v101
    v_lshrrev_b32 v6, 2, v1
    s_lshl_b32 s57, s59, 4
    v_add_u32 v6, s57, v6
    v_lshlrev_b32 v5, 3, v6
    v_add_u32 v5, 161792, v5
    v_mov_b32 v2, v4
    v_mov_b32 v3, v101
    ds_write_b64 v5, v[2:3]
    s_lshr_b32 s55, s2, 3
    s_mul_i32 s55, s55, 12
    s_add_u32 s55, s55, 128
    s_mul_i32 s55, s55, 2752
    s_bfe_u32 s56, s2, 0x10002
    s_mul_i32 s56, s56, 1472
    s_add_u32 s55, s55, s56
    v_and_b32 v2, 255, v0
    v_mul_u32_u24 v3, 5462, v2
    v_lshrrev_b32 v3, 16, v3
    v_mul_u32_u24 v4, 12, v3
    v_sub_u32 v4, v2, v4
    v_mul_u32_u24 v3, 2752, v3
    v_lshl_add_u32 v3, v4, 7, v3
    v_add_u32 v3, s55, v3
    v_cmp_gt_u32 vcc, 144, v2
    v_mov_b32 v4, 0x40000000
    s_nop 0
    v_cndmask_b32 v3, v4, v3, vcc
    buffer_load_dword v241, v3, s[20:23], 0 offen
    v_lshlrev_b32 v104, 16, v20
    v_lshlrev_b32 v110, 16, v22
    v_and_b32 v105, v249, v20
    v_and_b32 v111, v249, v22
    v_lshlrev_b32 v106, 16, v21
    v_lshlrev_b32 v112, 16, v23
    v_and_b32 v107, v249, v21
    v_and_b32 v113, v249, v23
    v_fma_f32 v104, v104, v101, v102
    v_fma_f32 v110, v110, v101, v102
    v_fma_f32 v105, v105, v101, v102
    v_fma_f32 v111, v111, v101, v102
    v_fma_f32 v106, v106, v101, v102
    v_fma_f32 v112, v112, v101, v102
    v_fma_f32 v107, v107, v101, v102
    v_fma_f32 v113, v113, v101, v102
    v_cvt_pk_bf16_f32 v20, v104, v105
    v_cvt_pk_bf16_f32 v22, v110, v111
    v_cvt_pk_bf16_f32 v21, v106, v107
    v_cvt_pk_bf16_f32 v23, v112, v113
    v_lshlrev_b32 v104, 16, v24
    v_lshlrev_b32 v110, 16, v26
    v_and_b32 v105, v249, v24
    v_and_b32 v111, v249, v26
    v_lshlrev_b32 v106, 16, v25
    v_lshlrev_b32 v112, 16, v27
    v_and_b32 v107, v249, v25
    v_and_b32 v113, v249, v27
    v_fma_f32 v104, v104, v101, v102
    v_fma_f32 v110, v110, v101, v102
    v_fma_f32 v105, v105, v101, v102
    v_fma_f32 v111, v111, v101, v102
    v_fma_f32 v106, v106, v101, v102
    v_fma_f32 v112, v112, v101, v102
    v_fma_f32 v107, v107, v101, v102
    v_fma_f32 v113, v113, v101, v102
    v_cvt_pk_bf16_f32 v24, v104, v105
    v_cvt_pk_bf16_f32 v26, v110, v111
    v_cvt_pk_bf16_f32 v25, v106, v107
    v_cvt_pk_bf16_f32 v27, v112, v113
    ds_write_b128 v116, v[20:23] offset:0
    ds_write_b128 v116, v[24:27] offset:1024
    v_lshlrev_b32 v104, 16, v28
    v_lshlrev_b32 v110, 16, v30
    v_and_b32 v105, v249, v28
    v_and_b32 v111, v249, v30
    v_lshlrev_b32 v106, 16, v29
    v_lshlrev_b32 v112, 16, v31
    v_and_b32 v107, v249, v29
    v_and_b32 v113, v249, v31
    v_fma_f32 v104, v104, v101, v102
    v_fma_f32 v110, v110, v101, v102
    v_fma_f32 v105, v105, v101, v102
    v_fma_f32 v111, v111, v101, v102
    v_fma_f32 v106, v106, v101, v102
    v_fma_f32 v112, v112, v101, v102
    v_fma_f32 v107, v107, v101, v102
    v_fma_f32 v113, v113, v101, v102
    v_cvt_pk_bf16_f32 v28, v104, v105
    v_cvt_pk_bf16_f32 v30, v110, v111
    v_cvt_pk_bf16_f32 v29, v106, v107
    v_cvt_pk_bf16_f32 v31, v112, v113
    v_lshlrev_b32 v104, 16, v32
    v_lshlrev_b32 v110, 16, v34
    v_and_b32 v105, v249, v32
    v_and_b32 v111, v249, v34
    v_lshlrev_b32 v106, 16, v33
    v_lshlrev_b32 v112, 16, v35
    v_and_b32 v107, v249, v33
    v_and_b32 v113, v249, v35
    v_fma_f32 v104, v104, v101, v102
    v_fma_f32 v110, v110, v101, v102
    v_fma_f32 v105, v105, v101, v102
    v_fma_f32 v111, v111, v101, v102
    v_fma_f32 v106, v106, v101, v102
    v_fma_f32 v112, v112, v101, v102
    v_fma_f32 v107, v107, v101, v102
    v_fma_f32 v113, v113, v101, v102
    v_cvt_pk_bf16_f32 v32, v104, v105
    v_cvt_pk_bf16_f32 v34, v110, v111
    v_cvt_pk_bf16_f32 v33, v106, v107
    v_cvt_pk_bf16_f32 v35, v112, v113
    ds_write_b128 v116, v[28:31] offset:8192
    ds_write_b128 v116, v[32:35] offset:9216
    buffer_load_dword v19, v7, s[44:47], 0 offen sc1
    v_lshlrev_b32 v104, 16, v36
    v_lshlrev_b32 v110, 16, v38
    v_and_b32 v105, v249, v36
    v_and_b32 v111, v249, v38
    v_lshlrev_b32 v106, 16, v37
    v_lshlrev_b32 v112, 16, v39
    v_and_b32 v107, v249, v37
    v_and_b32 v113, v249, v39
    v_fma_f32 v104, v104, v101, v102
    v_fma_f32 v110, v110, v101, v102
    v_fma_f32 v105, v105, v101, v102
    v_fma_f32 v111, v111, v101, v102
    v_fma_f32 v106, v106, v101, v102
    v_fma_f32 v112, v112, v101, v102
    v_fma_f32 v107, v107, v101, v102
    v_fma_f32 v113, v113, v101, v102
    v_cvt_pk_bf16_f32 v36, v104, v105
    v_cvt_pk_bf16_f32 v38, v110, v111
    v_cvt_pk_bf16_f32 v37, v106, v107
    v_cvt_pk_bf16_f32 v39, v112, v113
    v_lshlrev_b32 v104, 16, v40
    v_lshlrev_b32 v110, 16, v42
    v_and_b32 v105, v249, v40
    v_and_b32 v111, v249, v42
    v_lshlrev_b32 v106, 16, v41
    v_lshlrev_b32 v112, 16, v43
    v_and_b32 v107, v249, v41
    v_and_b32 v113, v249, v43
    v_fma_f32 v104, v104, v101, v102
    v_fma_f32 v110, v110, v101, v102
    v_fma_f32 v105, v105, v101, v102
    v_fma_f32 v111, v111, v101, v102
    v_fma_f32 v106, v106, v101, v102
    v_fma_f32 v112, v112, v101, v102
    v_fma_f32 v107, v107, v101, v102
    v_fma_f32 v113, v113, v101, v102
    v_cvt_pk_bf16_f32 v40, v104, v105
    v_cvt_pk_bf16_f32 v42, v110, v111
    v_cvt_pk_bf16_f32 v41, v106, v107
    v_cvt_pk_bf16_f32 v43, v112, v113
    ds_write_b128 v116, v[36:39] offset:16384
    ds_write_b128 v116, v[40:43] offset:17408
    v_lshlrev_b32 v104, 16, v44
    v_lshlrev_b32 v110, 16, v46
    v_and_b32 v105, v249, v44
    v_and_b32 v111, v249, v46
    v_lshlrev_b32 v106, 16, v45
    v_lshlrev_b32 v112, 16, v47
    v_and_b32 v107, v249, v45
    v_and_b32 v113, v249, v47
    v_fma_f32 v104, v104, v101, v102
    v_fma_f32 v110, v110, v101, v102
    v_fma_f32 v105, v105, v101, v102
    v_fma_f32 v111, v111, v101, v102
    v_fma_f32 v106, v106, v101, v102
    v_fma_f32 v112, v112, v101, v102
    v_fma_f32 v107, v107, v101, v102
    v_fma_f32 v113, v113, v101, v102
    v_cvt_pk_bf16_f32 v44, v104, v105
    v_cvt_pk_bf16_f32 v46, v110, v111
    v_cvt_pk_bf16_f32 v45, v106, v107
    v_cvt_pk_bf16_f32 v47, v112, v113
    v_lshlrev_b32 v104, 16, v48
    v_lshlrev_b32 v110, 16, v50
    v_and_b32 v105, v249, v48
    v_and_b32 v111, v249, v50
    v_lshlrev_b32 v106, 16, v49
    v_lshlrev_b32 v112, 16, v51
    v_and_b32 v107, v249, v49
    v_and_b32 v113, v249, v51
    v_fma_f32 v104, v104, v101, v102
    v_fma_f32 v110, v110, v101, v102
    v_fma_f32 v105, v105, v101, v102
    v_fma_f32 v111, v111, v101, v102
    v_fma_f32 v106, v106, v101, v102
    v_fma_f32 v112, v112, v101, v102
    v_fma_f32 v107, v107, v101, v102
    v_fma_f32 v113, v113, v101, v102
    v_cvt_pk_bf16_f32 v48, v104, v105
    v_cvt_pk_bf16_f32 v50, v110, v111
    v_cvt_pk_bf16_f32 v49, v106, v107
    v_cvt_pk_bf16_f32 v51, v112, v113
    ds_write_b128 v116, v[44:47] offset:24576
    ds_write_b128 v116, v[48:51] offset:25600
    v_lshlrev_b32 v104, 16, v52
    v_lshlrev_b32 v110, 16, v54
    v_and_b32 v105, v249, v52
    v_and_b32 v111, v249, v54
    v_lshlrev_b32 v106, 16, v53
    v_lshlrev_b32 v112, 16, v55
    v_and_b32 v107, v249, v53
    v_and_b32 v113, v249, v55
    v_fma_f32 v104, v104, v101, v102
    v_fma_f32 v110, v110, v101, v102
    v_fma_f32 v105, v105, v101, v102
    v_fma_f32 v111, v111, v101, v102
    v_fma_f32 v106, v106, v101, v102
    v_fma_f32 v112, v112, v101, v102
    v_fma_f32 v107, v107, v101, v102
    v_fma_f32 v113, v113, v101, v102
    v_cvt_pk_bf16_f32 v52, v104, v105
    v_cvt_pk_bf16_f32 v54, v110, v111
    v_cvt_pk_bf16_f32 v53, v106, v107
    v_cvt_pk_bf16_f32 v55, v112, v113
    v_lshlrev_b32 v104, 16, v56
    v_lshlrev_b32 v110, 16, v58
    v_and_b32 v105, v249, v56
    v_and_b32 v111, v249, v58
    v_lshlrev_b32 v106, 16, v57
    v_lshlrev_b32 v112, 16, v59
    v_and_b32 v107, v249, v57
    v_and_b32 v113, v249, v59
    v_fma_f32 v104, v104, v101, v102
    v_fma_f32 v110, v110, v101, v102
    v_fma_f32 v105, v105, v101, v102
    v_fma_f32 v111, v111, v101, v102
    v_fma_f32 v106, v106, v101, v102
    v_fma_f32 v112, v112, v101, v102
    v_fma_f32 v107, v107, v101, v102
    v_fma_f32 v113, v113, v101, v102
    v_cvt_pk_bf16_f32 v56, v104, v105
    v_cvt_pk_bf16_f32 v58, v110, v111
    v_cvt_pk_bf16_f32 v57, v106, v107
    v_cvt_pk_bf16_f32 v59, v112, v113
    v_lshlrev_b32 v104, 16, v60
    v_lshlrev_b32 v110, 16, v62
    v_and_b32 v105, v249, v60
    v_and_b32 v111, v249, v62
    v_lshlrev_b32 v106, 16, v61
    v_lshlrev_b32 v112, 16, v63
    v_and_b32 v107, v249, v61
    v_and_b32 v113, v249, v63
    v_fma_f32 v104, v104, v101, v102
    v_fma_f32 v110, v110, v101, v102
    v_fma_f32 v105, v105, v101, v102
    v_fma_f32 v111, v111, v101, v102
    v_fma_f32 v106, v106, v101, v102
    v_fma_f32 v112, v112, v101, v102
    v_fma_f32 v107, v107, v101, v102
    v_fma_f32 v113, v113, v101, v102
    v_cvt_pk_bf16_f32 v60, v104, v105
    v_cvt_pk_bf16_f32 v62, v110, v111
    v_cvt_pk_bf16_f32 v61, v106, v107
    v_cvt_pk_bf16_f32 v63, v112, v113
    v_lshlrev_b32 v104, 16, v64
    v_lshlrev_b32 v110, 16, v66
    v_and_b32 v105, v249, v64
    v_and_b32 v111, v249, v66
    v_lshlrev_b32 v106, 16, v65
    v_lshlrev_b32 v112, 16, v67
    v_and_b32 v107, v249, v65
    v_and_b32 v113, v249, v67
    v_fma_f32 v104, v104, v101, v102
    v_fma_f32 v110, v110, v101, v102
    v_fma_f32 v105, v105, v101, v102
    v_fma_f32 v111, v111, v101, v102
    v_fma_f32 v106, v106, v101, v102
    v_fma_f32 v112, v112, v101, v102
    v_fma_f32 v107, v107, v101, v102
    v_fma_f32 v113, v113, v101, v102
    v_cvt_pk_bf16_f32 v64, v104, v105
    v_cvt_pk_bf16_f32 v66, v110, v111
    v_cvt_pk_bf16_f32 v65, v106, v107
    v_cvt_pk_bf16_f32 v67, v112, v113
    v_lshlrev_b32 v104, 16, v68
    v_lshlrev_b32 v110, 16, v70
    v_and_b32 v105, v249, v68
    v_and_b32 v111, v249, v70
    v_lshlrev_b32 v106, 16, v69
    v_lshlrev_b32 v112, 16, v71
    v_and_b32 v107, v249, v69
    v_and_b32 v113, v249, v71
    v_fma_f32 v104, v104, v101, v102
    v_fma_f32 v110, v110, v101, v102
    v_fma_f32 v105, v105, v101, v102
    v_fma_f32 v111, v111, v101, v102
    v_fma_f32 v106, v106, v101, v102
    v_fma_f32 v112, v112, v101, v102
    v_fma_f32 v107, v107, v101, v102
    v_fma_f32 v113, v113, v101, v102
    v_cvt_pk_bf16_f32 v68, v104, v105
    v_cvt_pk_bf16_f32 v70, v110, v111
    v_cvt_pk_bf16_f32 v69, v106, v107
    v_cvt_pk_bf16_f32 v71, v112, v113
    v_lshlrev_b32 v104, 16, v72
    v_lshlrev_b32 v110, 16, v74
    v_and_b32 v105, v249, v72
    v_and_b32 v111, v249, v74
    v_lshlrev_b32 v106, 16, v73
    v_lshlrev_b32 v112, 16, v75
    v_and_b32 v107, v249, v73
    v_and_b32 v113, v249, v75
    v_fma_f32 v104, v104, v101, v102
    v_fma_f32 v110, v110, v101, v102
    v_fma_f32 v105, v105, v101, v102
    v_fma_f32 v111, v111, v101, v102
    v_fma_f32 v106, v106, v101, v102
    v_fma_f32 v112, v112, v101, v102
    v_fma_f32 v107, v107, v101, v102
    v_fma_f32 v113, v113, v101, v102
    v_cvt_pk_bf16_f32 v72, v104, v105
    v_cvt_pk_bf16_f32 v74, v110, v111
    v_cvt_pk_bf16_f32 v73, v106, v107
    v_cvt_pk_bf16_f32 v75, v112, v113
    v_lshlrev_b32 v104, 16, v76
    v_lshlrev_b32 v110, 16, v78
    v_and_b32 v105, v249, v76
    v_and_b32 v111, v249, v78
    v_lshlrev_b32 v106, 16, v77
    v_lshlrev_b32 v112, 16, v79
    v_and_b32 v107, v249, v77
    v_and_b32 v113, v249, v79
    v_fma_f32 v104, v104, v101, v102
    v_fma_f32 v110, v110, v101, v102
    v_fma_f32 v105, v105, v101, v102
    v_fma_f32 v111, v111, v101, v102
    v_fma_f32 v106, v106, v101, v102
    v_fma_f32 v112, v112, v101, v102
    v_fma_f32 v107, v107, v101, v102
    v_fma_f32 v113, v113, v101, v102
    v_cvt_pk_bf16_f32 v76, v104, v105
    v_cvt_pk_bf16_f32 v78, v110, v111
    v_cvt_pk_bf16_f32 v77, v106, v107
    v_cvt_pk_bf16_f32 v79, v112, v113
    v_lshlrev_b32 v104, 16, v80
    v_lshlrev_b32 v110, 16, v82
    v_and_b32 v105, v249, v80
    v_and_b32 v111, v249, v82
    v_lshlrev_b32 v106, 16, v81
    v_lshlrev_b32 v112, 16, v83
    v_and_b32 v107, v249, v81
    v_and_b32 v113, v249, v83
    v_fma_f32 v104, v104, v101, v102
    v_fma_f32 v110, v110, v101, v102
    v_fma_f32 v105, v105, v101, v102
    v_fma_f32 v111, v111, v101, v102
    v_fma_f32 v106, v106, v101, v102
    v_fma_f32 v112, v112, v101, v102
    v_fma_f32 v107, v107, v101, v102
    v_fma_f32 v113, v113, v101, v102
    v_cvt_pk_bf16_f32 v80, v104, v105
    v_cvt_pk_bf16_f32 v82, v110, v111
    v_cvt_pk_bf16_f32 v81, v106, v107
    v_cvt_pk_bf16_f32 v83, v112, v113
    s_waitcnt lgkmcnt(4)
    s_barrier
    s_waitcnt lgkmcnt(2)
    s_barrier
    ds_write_b128 v116, v[52:55] offset:0
    ds_write_b128 v116, v[56:59] offset:1024
    s_lshl_b32 s57, s49, 6
    s_lshl_b32 s56, s48, 1
    s_add_u32 s57, s57, s56
    s_lshl_b32 s57, s57, 12
    v_and_b32 v3, 255, v0
    v_lshlrev_b32 v3, 4, v3
    v_add_u32 v2, s57, v3
    v_add_u32 v4, -8, v2
    buffer_load_dwordx2 v[84:85], v4, s[32:35], 0 offen
    buffer_load_dwordx4 v[86:89], v2, s[32:35], 0 offen
    v_add_u32 v2, 4096, v2
    v_add_u32 v4, 4096, v4
    buffer_load_dwordx2 v[90:91], v4, s[32:35], 0 offen
    buffer_load_dwordx4 v[92:95], v2, s[32:35], 0 offen
    s_waitcnt lgkmcnt(2)
    s_barrier
    ds_write_b128 v116, v[60:63] offset:8192
    ds_write_b128 v116, v[64:67] offset:9216
    s_waitcnt lgkmcnt(2)
    s_barrier
    ds_write_b128 v116, v[68:71] offset:16384
    ds_write_b128 v116, v[72:75] offset:17408
    s_lshr_b32 s55, s2, 3
    v_and_b32 v2, 255, v0
    s_mul_i32 s55, s55, 43
    s_bfe_u32 s56, s2, 0x10002
    s_lshl_b32 s56, s56, 9
    s_lshl_b32 s55, s55, 10
    s_add_u32 s55, s55, s56
    v_lshrrev_b32 v3, 2, v2
    v_lshlrev_b32 v3, 10, v3
    v_and_b32 v4, 3, v2
    v_lshl_add_u32 v3, v4, 7, v3
    v_add_u32 v3, s55, v3
    v_cmp_gt_u32 vcc, 172, v2
    v_mov_b32 v4, 0x40000000
    s_nop 0
    v_cndmask_b32 v3, v4, v3, vcc
    buffer_load_dword v242, v3, s[24:27], 0 offen
    s_waitcnt lgkmcnt(2)
    s_barrier
    ds_write_b128 v116, v[76:79] offset:24576
    ds_write_b128 v116, v[80:83] offset:25600
    s_waitcnt vmcnt(5)
    v_readfirstlane_b32 s51, v19
    s_nop 3
    s_cmp_lg_u32 s51, 0
    s_cbranch_scc1 L_nz_18
    s_mov_b32 s58, 0
L_nl_19:
    v_mov_b32 v7, 0
    buffer_load_dword v19, v7, s[44:47], 0 offen sc1
    s_waitcnt vmcnt(0)
    v_readfirstlane_b32 s51, v19
    s_add_u32 s58, s58, 1
    s_cmp_gt_u32 s58, 100000
    s_cbranch_scc1 L_nz_18
    s_cmp_eq_u32 s51, 0
    s_cbranch_scc1 L_nl_19
L_nz_18:
    s_waitcnt lgkmcnt(2)
    s_barrier
    s_lshl_b32 s55, s49, 12
    s_add_u32 s55, s55, 0xa00000
    v_and_b32 v2, 31, v1
    v_lshlrev_b32 v2, 7, v2
    v_add_u32 v2, s55, v2
    buffer_load_dwordx4 v[96:99], v2, s[36:39], 0 offen sc1
    s_waitcnt lgkmcnt(0)
    s_barrier
    s_waitcnt vmcnt(0)
    v_xor_b32 v96, s51, v96
    v_xor_b32 v97, s51, v97
    v_xor_b32 v98, s51, v98
    v_xor_b32 v99, s51, v99
    v_or3_b32 v96, v96, v97, v98
    v_or_b32 v96, v96, v99
    v_cmp_ne_u32 vcc, 0, v96
    s_cbranch_vccz L_h1ok_20
    s_lshl_b32 s55, s49, 12
    s_add_u32 s55, s55, 0xa00000
    v_mul_u32_u24 v2, 128, v1
    v_add_u32 v2, s55, v2
    s_mov_b32 s58, 0
    s_mov_b32 exec_lo, -1
    s_mov_b32 exec_hi, 0
L_poll_21:
    buffer_load_dwordx4 v[4:7], v2, s[36:39], 0 offen sc1
    s_waitcnt vmcnt(0)
    v_xor_b32 v4, s51, v4
    v_xor_b32 v5, s51, v5
    v_xor_b32 v6, s51, v6
    v_xor_b32 v7, s51, v7
    v_or3_b32 v4, v4, v5, v6
    v_or_b32 v4, v4, v7
    v_cmp_ne_u32 vcc, 0, v4
    s_add_u32 s58, s58, 1
    s_cmp_gt_u32 s58, 100000
    s_cbranch_scc1 L_pdone_22
    s_cbranch_vccnz L_poll_21
L_pdone_22:
    s_mov_b64 exec, -1
L_h1ok_20:
    s_lshl_b32 s55, s49, 6
    s_lshl_b32 s56, s48, 1
    s_add_u32 s55, s55, s56
    s_lshl_b32 s55, s55, 12
    s_lshl_b32 s56, s59, 11
    s_add_u32 s55, s55, s56
    v_lshlrev_b32 v4, 4, v1
    v_add_u32 v5, s55, v4
    buffer_load_dwordx4 v[20:23], v5, s[36:39], 0 offen sc1
    buffer_load_dwordx4 v[24:27], v5, s[36:39], 0 offen offset:1024 sc1
    v_alignbit_b32 v118, v85, v84, 16
    v_alignbit_b32 v119, v86, v85, 16
    v_alignbit_b32 v120, v87, v86, 16
    v_alignbit_b32 v121, v88, v87, 16
    v_alignbit_b32 v122, v89, v88, 16
    v_mov_b32 v124, v85
    v_mov_b32 v128, v119
    v_mov_b32 v125, v86
    v_mov_b32 v129, v120
    v_mov_b32 v126, v87
    v_mov_b32 v130, v121
    v_mov_b32 v127, v88
    v_mov_b32 v131, v122
    v_and_b32 v3, 255, v0
    v_lshlrev_b32 v3, 4, v3
    v_add_u32 v3, 106528, v3
    ds_write_b128 v3, v[118:121]
    ds_write_b128 v3, v[124:127] offset:4160
    ds_write_b128 v3, v[128:131] offset:8320
    ds_write_b128 v3, v[86:89] offset:12480
    v_alignbit_b32 v118, v91, v90, 16
    v_alignbit_b32 v119, v92, v91, 16
    v_alignbit_b32 v120, v93, v92, 16
    v_alignbit_b32 v121, v94, v93, 16
    v_alignbit_b32 v122, v95, v94, 16
    v_mov_b32 v124, v91
    v_mov_b32 v128, v119
    v_mov_b32 v125, v92
    v_mov_b32 v129, v120
    v_mov_b32 v126, v93
    v_mov_b32 v130, v121
    v_mov_b32 v127, v94
    v_mov_b32 v131, v122
    v_and_b32 v3, 255, v0
    v_lshlrev_b32 v3, 4, v3
    v_add_u32 v3, 123168, v3
    ds_write_b128 v3, v[118:121]
    ds_write_b128 v3, v[124:127] offset:4160
    ds_write_b128 v3, v[128:131] offset:8320
    ds_write_b128 v3, v[92:95] offset:12480
    v_lshlrev_b32 v4, 4, v1
    s_lshr_b32 s55, s59, 1
    s_mul_i32 s55, s55, 4608
    s_and_b32 s56, s59, 1
    s_lshl_b32 s57, s56, 11
    s_add_u32 s55, s55, s57
    s_add_u32 s55, s55, 139904
    v_add_u32 v6, s55, v4
    v_mov_b32 v28, 0
    v_mov_b32 v29, 0
    v_mov_b32 v30, 0
    v_mov_b32 v31, 0
    s_cmp_eq_u32 s56, 1
    s_cselect_b32 exec_lo, -1, 0
    s_mov_b32 exec_hi, 0
    ds_write_b128 v6, v[28:31] offset:2048
    s_mov_b64 exec, -1
    s_waitcnt vmcnt(0)
    ds_write_b128 v6, v[20:23]
    ds_write_b128 v6, v[24:27] offset:1024
    v_lshrrev_b32 v2, 3, v1
    v_and_b32 v2, 3, v2
    v_lshrrev_b32 v3, 5, v1
    v_lshl_add_u32 v2, v3, 3, v2
    v_lshlrev_b32 v2, 10, v2
    v_lshrrev_b32 v3, 4, v1
    v_and_b32 v3, 3, v3
    v_lshlrev_b32 v3, 1, v3
    v_and_b32 v4, 7, v1
    v_xor_b32 v3, v3, v4
    v_lshl_add_u32 v2, v3, 4, v2
    s_lshl_b32 s55, s85, 7
    v_add_u32 v14, s55, v2
    s_waitcnt lgkmcnt(0)
    s_barrier
    s_lshr_b32 s75, s59, 1
    s_and_b32 s76, s59, 1
    s_add_u32 s55, s59, 0
    s_lshr_b32 s56, s55, 1
    s_and_b32 s55, s55, 1
    s_mul_i32 s71, s55, 13
    s_add_u32 s71, s71, s56
    s_lshl_b32 s71, s71, 12
    s_mul_i32 s70, s55, 22
    s_add_u32 s70, s70, s56
    s_lshl_b32 s70, s70, 15
    s_add_u32 s57, s70, 0
    s_add_u32 m0, s71, 0
    s_nop 0
    buffer_load_dwordx4 v14, s[24:27], s57 offen lds
    s_add_u32 m0, s71, 1024
    s_add_u32 s57, s57, 4096
    buffer_load_dwordx4 v14, s[24:27], s57 offen lds
    s_add_u32 m0, s71, 2048
    s_add_u32 s57, s57, 12288
    buffer_load_dwordx4 v14, s[24:27], s57 offen lds
    s_add_u32 m0, s71, 3072
    s_add_u32 s57, s57, 4096
    buffer_load_dwordx4 v14, s[24:27], s57 offen lds
    s_add_u32 s55, s59, 4
    s_lshr_b32 s56, s55, 1
    s_and_b32 s55, s55, 1
    s_mul_i32 s71, s55, 13
    s_add_u32 s71, s71, s56
    s_lshl_b32 s71, s71, 12
    s_mul_i32 s70, s55, 22
    s_add_u32 s70, s70, s56
    s_lshl_b32 s70, s70, 15
    s_add_u32 s57, s70, 0
    s_add_u32 m0, s71, 0
    s_nop 0
    buffer_load_dwordx4 v14, s[24:27], s57 offen lds
    s_add_u32 m0, s71, 1024
    s_add_u32 s57, s57, 4096
    buffer_load_dwordx4 v14, s[24:27], s57 offen lds
    s_add_u32 m0, s71, 2048
    s_add_u32 s57, s57, 12288
    buffer_load_dwordx4 v14, s[24:27], s57 offen lds
    s_add_u32 m0, s71, 3072
    s_add_u32 s57, s57, 4096
    buffer_load_dwordx4 v14, s[24:27], s57 offen lds
    s_add_u32 s55, s59, 8
    s_lshr_b32 s56, s55, 1
    s_and_b32 s55, s55, 1
    s_mul_i32 s71, s55, 13
    s_add_u32 s71, s71, s56
    s_lshl_b32 s71, s71, 12
    s_mul_i32 s70, s55, 22
    s_add_u32 s70, s70, s56
    s_lshl_b32 s70, s70, 15
    s_add_u32 s57, s70, 0
    s_add_u32 m0, s71, 0
    s_nop 0
    buffer_load_dwordx4 v14, s[24:27], s57 offen lds
    s_add_u32 m0, s71, 1024
    s_add_u32 s57, s57, 4096
    buffer_load_dwordx4 v14, s[24:27], s57 offen lds
    s_add_u32 m0, s71, 2048
    s_add_u32 s57, s57, 12288
    buffer_load_dwordx4 v14, s[24:27], s57 offen lds
    s_add_u32 m0, s71, 3072
    s_add_u32 s57, s57, 4096
    buffer_load_dwordx4 v14, s[24:27], s57 offen lds
    s_add_u32 s55, s59, 12
    s_lshr_b32 s56, s55, 1
    s_and_b32 s55, s55, 1
    s_mul_i32 s71, s55, 13
    s_add_u32 s71, s71, s56
    s_lshl_b32 s71, s71, 12
    s_mul_i32 s70, s55, 22
    s_add_u32 s70, s70, s56
    s_lshl_b32 s70, s70, 15
    s_add_u32 s57, s70, 0
    s_add_u32 m0, s71, 0
    s_nop 0
    buffer_load_dwordx4 v14, s[24:27], s57 offen lds
    s_add_u32 m0, s71, 1024
    s_add_u32 s57, s57, 4096
    buffer_load_dwordx4 v14, s[24:27], s57 offen lds
    s_add_u32 m0, s71, 2048
    s_add_u32 s57, s57, 12288
    buffer_load_dwordx4 v14, s[24:27], s57 offen lds
    s_add_u32 m0, s71, 3072
    s_add_u32 s57, s57, 4096
    buffer_load_dwordx4 v14, s[24:27], s57 offen lds
    s_add_u32 s55, s59, 16
    s_lshr_b32 s56, s55, 1
    s_and_b32 s55, s55, 1
    s_mul_i32 s71, s55, 13
    s_add_u32 s71, s71, s56
    s_lshl_b32 s71, s71, 12
    s_mul_i32 s70, s55, 22
    s_add_u32 s70, s70, s56
    s_lshl_b32 s70, s70, 15
    s_add_u32 s57, s70, 0
    s_add_u32 m0, s71, 0
    s_nop 0
    buffer_load_dwordx4 v14, s[24:27], s57 offen lds
    s_add_u32 m0, s71, 1024
    s_add_u32 s57, s57, 4096
    buffer_load_dwordx4 v14, s[24:27], s57 offen lds
    s_add_u32 m0, s71, 2048
    s_add_u32 s57, s57, 12288
    buffer_load_dwordx4 v14, s[24:27], s57 offen lds
    s_add_u32 m0, s71, 3072
    s_add_u32 s57, s57, 4096
    buffer_load_dwordx4 v14, s[24:27], s57 offen lds
    s_add_u32 s55, s59, 20
    s_lshr_b32 s56, s55, 1
    s_and_b32 s55, s55, 1
    s_mul_i32 s71, s55, 13
    s_add_u32 s71, s71, s56
    s_lshl_b32 s71, s71, 12
    s_mul_i32 s70, s55, 22
    s_add_u32 s70, s70, s56
    s_lshl_b32 s70, s70, 15
    s_add_u32 s57, s70, 0
    s_add_u32 m0, s71, 0
    s_nop 0
    buffer_load_dwordx4 v14, s[24:27], s57 offen lds
    s_add_u32 m0, s71, 1024
    s_add_u32 s57, s57, 4096
    buffer_load_dwordx4 v14, s[24:27], s57 offen lds
    s_add_u32 m0, s71, 2048
    s_add_u32 s57, s57, 12288
    buffer_load_dwordx4 v14, s[24:27], s57 offen lds
    s_add_u32 m0, s71, 3072
    s_add_u32 s57, s57, 4096
    buffer_load_dwordx4 v14, s[24:27], s57 offen lds
    s_add_u32 s55, s59, 24
    s_min_u32 s55, s55, 25
    s_lshr_b32 s56, s55, 1
    s_and_b32 s55, s55, 1
    s_mul_i32 s71, s55, 13
    s_add_u32 s71, s71, s56
    s_lshl_b32 s71, s71, 12
    s_mul_i32 s70, s55, 22
    s_add_u32 s70, s70, s56
    s_lshl_b32 s70, s70, 15
    s_add_u32 s57, s70, 0
    s_add_u32 m0, s71, 0
    s_nop 0
    buffer_load_dwordx4 v14, s[24:27], s57 offen lds
    s_add_u32 m0, s71, 1024
    s_add_u32 s57, s57, 4096
    buffer_load_dwordx4 v14, s[24:27], s57 offen lds
    s_add_u32 m0, s71, 2048
    s_add_u32 s57, s57, 12288
    buffer_load_dwordx4 v14, s[24:27], s57 offen lds
    s_add_u32 m0, s71, 3072
    s_add_u32 s57, s57, 4096
    buffer_load_dwordx4 v14, s[24:27], s57 offen lds
    s_lshl_b32 s57, s48, 2
    s_lshl_b32 s4, s76, 1
    s_add_u32 s57, s57, s4
    s_mul_i32 s57, s57, 44032
    s_mul_i32 s4, s75, 22528
    s_add_u32 s57, s57, s4
    s_add_u32 s57, s57, 0x400000
    v_lshlrev_b32 v18, 4, v1
    v_add_u32 v18, s57, v18
    v_add_u32 v19, 44032, v18
    v_lshrrev_b32 v2, 4, v1
    v_and_b32 v3, 15, v1
    v_lshrrev_b32 v3, 2, v3
    v_lshrrev_b32 v4, 1, v2
    v_lshlrev_b32 v4, 4, v4
    v_and_b32 v5, 1, v2
    v_lshl_add_u32 v4, v5, 2, v4
    v_add_u32 v4, v4, v3
    v_lshlrev_b32 v4, 7, v4
    v_and_b32 v6, 1, v1
    v_lshl_add_u32 v4, v6, 3, v4
    v_lshlrev_b32 v5, 1, v5
    v_lshrrev_b32 v6, 1, v3
    v_add_u32 v5, v5, v6
    v_lshlrev_b32 v5, 1, v5
    v_and_b32 v6, 3, v1
    v_lshrrev_b32 v6, 1, v6
    s_mul_i32 s4, s75, 53248
    v_add_u32 v7, 0, v6
    v_xor_b32 v7, v7, v5
    v_lshl_add_u32 v7, v7, 4, v4
    v_add_u32 v244, s4, v7
    v_add_u32 v7, 2, v6
    v_xor_b32 v7, v7, v5
    v_lshl_add_u32 v7, v7, 4, v4
    v_add_u32 v245, s4, v7
    v_add_u32 v7, 4, v6
    v_xor_b32 v7, v7, v5
    v_lshl_add_u32 v7, v7, 4, v4
    v_add_u32 v246, s4, v7
    v_add_u32 v7, 6, v6
    v_xor_b32 v7, v7, v5
    v_lshl_add_u32 v7, v7, 4, v4
    v_add_u32 v247, s4, v7
    s_mul_i32 s5, s75, 24576
    s_add_u32 s5, s5, 106496
    s_sub_u32 s77, s5, s4
    s_sub_u32 s79, s4, s5
    v_mov_b32 v196, 0
    v_mov_b32 v197, 0
    v_mov_b32 v198, 0
    v_mov_b32 v199, 0
    v_mov_b32 v200, 0
    v_mov_b32 v201, 0
    v_mov_b32 v202, 0
    v_mov_b32 v203, 0
    v_mov_b32 v204, 0
    v_mov_b32 v205, 0
    v_mov_b32 v206, 0
    v_mov_b32 v207, 0
    v_mov_b32 v208, 0
    v_mov_b32 v209, 0
    v_mov_b32 v210, 0
    v_mov_b32 v211, 0
    v_mov_b32 v212, 0
    v_mov_b32 v213, 0
    v_mov_b32 v214, 0
    v_mov_b32 v215, 0
    v_mov_b32 v216, 0
    v_mov_b32 v217, 0
    v_mov_b32 v218, 0
    v_mov_b32 v219, 0
    v_mov_b32 v220, 0
    v_mov_b32 v221, 0
    v_mov_b32 v222, 0
    v_mov_b32 v223, 0
    v_mov_b32 v224, 0
    v_mov_b32 v225, 0
    v_mov_b32 v226, 0
    v_mov_b32 v227, 0
    s_lshl_b32 s55, s48, 10
    s_add_u32 s55, s55, 0xa08000
    v_mul_u32_u24 v2, 128, v1
    v_add_u32 v2, s55, v2
    s_mov_b32 s58, 0
    s_mov_b64 exec, 0xff
L_poll_23:
    buffer_load_dwordx4 v[4:7], v2, s[36:39], 0 offen sc1
    s_waitcnt vmcnt(0)
    v_xor_b32 v4, s51, v4
    v_xor_b32 v5, s51, v5
    v_xor_b32 v6, s51, v6
    v_xor_b32 v7, s51, v7
    v_or3_b32 v4, v4, v5, v6
    v_or_b32 v4, v4, v7
    v_cmp_ne_u32 vcc, 0, v4
    s_add_u32 s58, s58, 1
    s_cmp_gt_u32 s58, 100000
    s_cbranch_scc1 L_pdone_24
    s_cbranch_vccnz L_poll_23
L_pdone_24:
    s_mov_b64 exec, -1
    buffer_load_dwordx4 v[20:23], v18, s[36:39], 0 offen offset:0 sc1
    buffer_load_dwordx4 v[24:27], v19, s[36:39], 0 offen offset:0 sc1
    buffer_load_dwordx4 v[28:31], v18, s[36:39], 0 offen offset:1024 sc1
    buffer_load_dwordx4 v[32:35], v19, s[36:39], 0 offen offset:1024 sc1
    buffer_load_dwordx4 v[36:39], v18, s[36:39], 0 offen offset:2048 sc1
    buffer_load_dwordx4 v[40:43], v19, s[36:39], 0 offen offset:2048 sc1
    s_waitcnt vmcnt(6)
    v_mov_b32 v253, 162348
    v_mov_b32 v254, 1
    s_waitcnt lgkmcnt(0)
    s_mov_b64 exec, 1
    ds_add_u32 v253, v254
    s_mov_b64 exec, -1
    s_mov_b32 s5, 162348
    v_mov_b32 v253, s5
    s_mov_b32 s58, 0
L_ps_25:
    ds_read_b32 v254, v253
    s_waitcnt lgkmcnt(0)
    v_readfirstlane_b32 s4, v254
    s_add_u32 s58, s58, 1
    s_cmp_ge_u32 s4, 4
    s_cbranch_scc1 L_psd_26
    s_cmp_lt_u32 s58, 1000000
    s_cbranch_scc1 L_ps_25
L_psd_26:
    ds_read_b64_tr_b16 v[228:229], v244 offset:0
    ds_read_b64_tr_b16 v[230:231], v244 offset:1024
    ds_read_b64_tr_b16 v[232:233], v245 offset:0
    ds_read_b64_tr_b16 v[234:235], v245 offset:1024
    ds_read_b64_tr_b16 v[236:237], v246 offset:0
    ds_read_b64_tr_b16 v[238:239], v246 offset:1024
    ds_read_b64_tr_b16 v[240:241], v247 offset:0
    ds_read_b64_tr_b16 v[242:243], v247 offset:1024
    s_waitcnt vmcnt(4) lgkmcnt(0)
    v_mfma_f32_16x16x32_bf16 v[196:199], v[228:231], v[20:23], v[196:199]
    buffer_load_dwordx4 v[44:47], v18, s[36:39], 0 offen offset:3072 sc1
    v_mfma_f32_16x16x32_bf16 v[200:203], v[228:231], v[24:27], v[200:203]
    buffer_load_dwordx4 v[48:51], v19, s[36:39], 0 offen offset:3072 sc1
    s_mov_b32 s80, 4096
    buffer_load_dwordx4 v[52:55], v18, s[36:39], s80 offen offset:0 sc1
    v_mfma_f32_16x16x32_bf16 v[204:207], v[232:235], v[20:23], v[204:207]
    buffer_load_dwordx4 v[56:59], v19, s[36:39], s80 offen offset:0 sc1
    v_mfma_f32_16x16x32_bf16 v[208:211], v[232:235], v[24:27], v[208:211]
    ds_read_b64_tr_b16 v[2:3], v244 offset:4096
    ds_read_b64_tr_b16 v[4:5], v244 offset:5120
    v_mfma_f32_16x16x32_bf16 v[212:215], v[236:239], v[20:23], v[212:215]
    ds_read_b64_tr_b16 v[6:7], v245 offset:4096
    v_mfma_f32_16x16x32_bf16 v[216:219], v[236:239], v[24:27], v[216:219]
    ds_read_b64_tr_b16 v[8:9], v245 offset:5120
    ds_read_b64_tr_b16 v[10:11], v246 offset:4096
    v_mfma_f32_16x16x32_bf16 v[220:223], v[240:243], v[20:23], v[220:223]
    ds_read_b64_tr_b16 v[12:13], v246 offset:5120
    v_mfma_f32_16x16x32_bf16 v[224:227], v[240:243], v[24:27], v[224:227]
    ds_read_b64_tr_b16 v[14:15], v247 offset:4096
    ds_read_b64_tr_b16 v[16:17], v247 offset:5120
    s_waitcnt vmcnt(6) lgkmcnt(0)
    v_mfma_f32_16x16x32_bf16 v[196:199], v[2:5], v[28:31], v[196:199]
    s_mov_b32 s80, 4096
    buffer_load_dwordx4 v[60:63], v18, s[36:39], s80 offen offset:1024 sc1
    v_mfma_f32_16x16x32_bf16 v[200:203], v[2:5], v[32:35], v[200:203]
    buffer_load_dwordx4 v[64:67], v19, s[36:39], s80 offen offset:1024 sc1
    s_mov_b32 s80, 4096
    buffer_load_dwordx4 v[68:71], v18, s[36:39], s80 offen offset:2048 sc1
    v_mfma_f32_16x16x32_bf16 v[204:207], v[6:9], v[28:31], v[204:207]
    buffer_load_dwordx4 v[72:75], v19, s[36:39], s80 offen offset:2048 sc1
    v_mfma_f32_16x16x32_bf16 v[208:211], v[6:9], v[32:35], v[208:211]
    ds_read_b64_tr_b16 v[228:229], v244 offset:8192
    ds_read_b64_tr_b16 v[230:231], v244 offset:9216
    v_mfma_f32_16x16x32_bf16 v[212:215], v[10:13], v[28:31], v[212:215]
    ds_read_b64_tr_b16 v[232:233], v245 offset:8192
    v_mfma_f32_16x16x32_bf16 v[216:219], v[10:13], v[32:35], v[216:219]
    ds_read_b64_tr_b16 v[234:235], v245 offset:9216
    ds_read_b64_tr_b16 v[236:237], v246 offset:8192
    v_mfma_f32_16x16x32_bf16 v[220:223], v[14:17], v[28:31], v[220:223]
    ds_read_b64_tr_b16 v[238:239], v246 offset:9216
    v_mfma_f32_16x16x32_bf16 v[224:227], v[14:17], v[32:35], v[224:227]
    ds_read_b64_tr_b16 v[240:241], v247 offset:8192
    ds_read_b64_tr_b16 v[242:243], v247 offset:9216
    s_waitcnt vmcnt(8) lgkmcnt(0)
    v_mfma_f32_16x16x32_bf16 v[196:199], v[228:231], v[36:39], v[196:199]
    s_mov_b32 s80, 4096
    buffer_load_dwordx4 v[76:79], v18, s[36:39], s80 offen offset:3072 sc1
    v_mfma_f32_16x16x32_bf16 v[200:203], v[228:231], v[40:43], v[200:203]
    buffer_load_dwordx4 v[80:83], v19, s[36:39], s80 offen offset:3072 sc1
    s_mov_b32 s80, 8192
    buffer_load_dwordx4 v[84:87], v18, s[36:39], s80 offen offset:0 sc1
    v_mfma_f32_16x16x32_bf16 v[204:207], v[232:235], v[36:39], v[204:207]
    buffer_load_dwordx4 v[88:91], v19, s[36:39], s80 offen offset:0 sc1
    v_mfma_f32_16x16x32_bf16 v[208:211], v[232:235], v[40:43], v[208:211]
    ds_read_b64_tr_b16 v[2:3], v244 offset:12288
    ds_read_b64_tr_b16 v[4:5], v244 offset:13312
    v_mfma_f32_16x16x32_bf16 v[212:215], v[236:239], v[36:39], v[212:215]
    ds_read_b64_tr_b16 v[6:7], v245 offset:12288
    v_mfma_f32_16x16x32_bf16 v[216:219], v[236:239], v[40:43], v[216:219]
    ds_read_b64_tr_b16 v[8:9], v245 offset:13312
    ds_read_b64_tr_b16 v[10:11], v246 offset:12288
    v_mfma_f32_16x16x32_bf16 v[220:223], v[240:243], v[36:39], v[220:223]
    ds_read_b64_tr_b16 v[12:13], v246 offset:13312
    v_mfma_f32_16x16x32_bf16 v[224:227], v[240:243], v[40:43], v[224:227]
    ds_read_b64_tr_b16 v[14:15], v247 offset:12288
    ds_read_b64_tr_b16 v[16:17], v247 offset:13312
    s_waitcnt vmcnt(10) lgkmcnt(0)
    v_mfma_f32_16x16x32_bf16 v[196:199], v[2:5], v[44:47], v[196:199]
    s_mov_b32 s80, 8192
    buffer_load_dwordx4 v[92:95], v18, s[36:39], s80 offen offset:1024 sc1
    v_mfma_f32_16x16x32_bf16 v[200:203], v[2:5], v[48:51], v[200:203]
    buffer_load_dwordx4 v[96:99], v19, s[36:39], s80 offen offset:1024 sc1
    s_mov_b32 s80, 8192
    buffer_load_dwordx4 v[100:103], v18, s[36:39], s80 offen offset:2048 sc1
    v_mfma_f32_16x16x32_bf16 v[204:207], v[6:9], v[44:47], v[204:207]
    buffer_load_dwordx4 v[104:107], v19, s[36:39], s80 offen offset:2048 sc1
    v_mfma_f32_16x16x32_bf16 v[208:211], v[6:9], v[48:51], v[208:211]
    ds_read_b64_tr_b16 v[228:229], v244 offset:16384
    ds_read_b64_tr_b16 v[230:231], v244 offset:17408
    v_mfma_f32_16x16x32_bf16 v[212:215], v[10:13], v[44:47], v[212:215]
    ds_read_b64_tr_b16 v[232:233], v245 offset:16384
    v_mfma_f32_16x16x32_bf16 v[216:219], v[10:13], v[48:51], v[216:219]
    ds_read_b64_tr_b16 v[234:235], v245 offset:17408
    ds_read_b64_tr_b16 v[236:237], v246 offset:16384
    v_mfma_f32_16x16x32_bf16 v[220:223], v[14:17], v[44:47], v[220:223]
    ds_read_b64_tr_b16 v[238:239], v246 offset:17408
    v_mfma_f32_16x16x32_bf16 v[224:227], v[14:17], v[48:51], v[224:227]
    ds_read_b64_tr_b16 v[240:241], v247 offset:16384
    ds_read_b64_tr_b16 v[242:243], v247 offset:17408
    v_mov_b32 v253, 162360
    v_mov_b32 v254, 1
    s_mov_b64 exec, 1
    ds_add_u32 v253, v254
    s_mov_b64 exec, -1
    s_waitcnt vmcnt(12) lgkmcnt(1)
    v_mfma_f32_16x16x32_bf16 v[196:199], v[228:231], v[52:55], v[196:199]
    s_mov_b32 s80, 8192
    buffer_load_dwordx4 v[108:111], v18, s[36:39], s80 offen offset:3072 sc1
    v_mfma_f32_16x16x32_bf16 v[200:203], v[228:231], v[56:59], v[200:203]
    buffer_load_dwordx4 v[112:115], v19, s[36:39], s80 offen offset:3072 sc1
    s_mov_b32 s80, 12288
    buffer_load_dwordx4 v[116:119], v18, s[36:39], s80 offen offset:0 sc1
    v_mfma_f32_16x16x32_bf16 v[204:207], v[232:235], v[52:55], v[204:207]
    buffer_load_dwordx4 v[120:123], v19, s[36:39], s80 offen offset:0 sc1
    v_mfma_f32_16x16x32_bf16 v[208:211], v[232:235], v[56:59], v[208:211]
    ds_read_b64_tr_b16 v[2:3], v244 offset:20480
    ds_read_b64_tr_b16 v[4:5], v244 offset:21504
    v_mfma_f32_16x16x32_bf16 v[212:215], v[236:239], v[52:55], v[212:215]
    ds_read_b64_tr_b16 v[6:7], v245 offset:20480
    v_mfma_f32_16x16x32_bf16 v[216:219], v[236:239], v[56:59], v[216:219]
    ds_read_b64_tr_b16 v[8:9], v245 offset:21504
    ds_read_b64_tr_b16 v[10:11], v246 offset:20480
    v_mfma_f32_16x16x32_bf16 v[220:223], v[240:243], v[52:55], v[220:223]
    ds_read_b64_tr_b16 v[12:13], v246 offset:21504
    v_mfma_f32_16x16x32_bf16 v[224:227], v[240:243], v[56:59], v[224:227]
    ds_read_b64_tr_b16 v[14:15], v247 offset:20480
    ds_read_b64_tr_b16 v[16:17], v247 offset:21504
    s_waitcnt vmcnt(14) lgkmcnt(0)
    v_mfma_f32_16x16x32_bf16 v[196:199], v[2:5], v[60:63], v[196:199]
    s_mov_b32 s80, 12288
    buffer_load_dwordx4 v[124:127], v18, s[36:39], s80 offen offset:1024 sc1
    v_mfma_f32_16x16x32_bf16 v[200:203], v[2:5], v[64:67], v[200:203]
    buffer_load_dwordx4 v[128:131], v19, s[36:39], s80 offen offset:1024 sc1
    s_mov_b32 s80, 12288
    buffer_load_dwordx4 v[132:135], v18, s[36:39], s80 offen offset:2048 sc1
    v_mfma_f32_16x16x32_bf16 v[204:207], v[6:9], v[60:63], v[204:207]
    buffer_load_dwordx4 v[136:139], v19, s[36:39], s80 offen offset:2048 sc1
    v_mfma_f32_16x16x32_bf16 v[208:211], v[6:9], v[64:67], v[208:211]
    ds_read_b64_tr_b16 v[228:229], v244 offset:24576
    ds_read_b64_tr_b16 v[230:231], v244 offset:25600
    v_mfma_f32_16x16x32_bf16 v[212:215], v[10:13], v[60:63], v[212:215]
    ds_read_b64_tr_b16 v[232:233], v245 offset:24576
    v_mfma_f32_16x16x32_bf16 v[216:219], v[10:13], v[64:67], v[216:219]
    ds_read_b64_tr_b16 v[234:235], v245 offset:25600
    ds_read_b64_tr_b16 v[236:237], v246 offset:24576
    v_mfma_f32_16x16x32_bf16 v[220:223], v[14:17], v[60:63], v[220:223]
    ds_read_b64_tr_b16 v[238:239], v246 offset:25600
    v_mfma_f32_16x16x32_bf16 v[224:227], v[14:17], v[64:67], v[224:227]
    ds_read_b64_tr_b16 v[240:241], v247 offset:24576
    ds_read_b64_tr_b16 v[242:243], v247 offset:25600
    s_waitcnt vmcnt(16) lgkmcnt(0)
    v_mfma_f32_16x16x32_bf16 v[196:199], v[228:231], v[68:71], v[196:199]
    s_mov_b32 s80, 12288
    buffer_load_dwordx4 v[140:143], v18, s[36:39], s80 offen offset:3072 sc1
    v_mfma_f32_16x16x32_bf16 v[200:203], v[228:231], v[72:75], v[200:203]
    buffer_load_dwordx4 v[144:147], v19, s[36:39], s80 offen offset:3072 sc1
    s_mov_b32 s80, 16384
    buffer_load_dwordx4 v[148:151], v18, s[36:39], s80 offen offset:0 sc1
    v_mfma_f32_16x16x32_bf16 v[204:207], v[232:235], v[68:71], v[204:207]
    buffer_load_dwordx4 v[152:155], v19, s[36:39], s80 offen offset:0 sc1
    v_mfma_f32_16x16x32_bf16 v[208:211], v[232:235], v[72:75], v[208:211]
    ds_read_b64_tr_b16 v[2:3], v244 offset:28672
    ds_read_b64_tr_b16 v[4:5], v244 offset:29696
    v_mfma_f32_16x16x32_bf16 v[212:215], v[236:239], v[68:71], v[212:215]
    ds_read_b64_tr_b16 v[6:7], v245 offset:28672
    v_mfma_f32_16x16x32_bf16 v[216:219], v[236:239], v[72:75], v[216:219]
    ds_read_b64_tr_b16 v[8:9], v245 offset:29696
    ds_read_b64_tr_b16 v[10:11], v246 offset:28672
    v_mfma_f32_16x16x32_bf16 v[220:223], v[240:243], v[68:71], v[220:223]
    ds_read_b64_tr_b16 v[12:13], v246 offset:29696
    v_mfma_f32_16x16x32_bf16 v[224:227], v[240:243], v[72:75], v[224:227]
    ds_read_b64_tr_b16 v[14:15], v247 offset:28672
    ds_read_b64_tr_b16 v[16:17], v247 offset:29696
    s_waitcnt vmcnt(18) lgkmcnt(0)
    v_mfma_f32_16x16x32_bf16 v[196:199], v[2:5], v[76:79], v[196:199]
    s_mov_b32 s80, 16384
    buffer_load_dwordx4 v[156:159], v18, s[36:39], s80 offen offset:1024 sc1
    v_mfma_f32_16x16x32_bf16 v[200:203], v[2:5], v[80:83], v[200:203]
    buffer_load_dwordx4 v[160:163], v19, s[36:39], s80 offen offset:1024 sc1
    v_mfma_f32_16x16x32_bf16 v[204:207], v[6:9], v[76:79], v[204:207]
    ds_read_b64_tr_b16 v[228:229], v244 offset:32768
    v_mfma_f32_16x16x32_bf16 v[208:211], v[6:9], v[80:83], v[208:211]
    ds_read_b64_tr_b16 v[230:231], v244 offset:33792
    ds_read_b64_tr_b16 v[232:233], v245 offset:32768
    v_mfma_f32_16x16x32_bf16 v[212:215], v[10:13], v[76:79], v[212:215]
    ds_read_b64_tr_b16 v[234:235], v245 offset:33792
    v_mfma_f32_16x16x32_bf16 v[216:219], v[10:13], v[80:83], v[216:219]
    ds_read_b64_tr_b16 v[236:237], v246 offset:32768
    v_mfma_f32_16x16x32_bf16 v[220:223], v[14:17], v[76:79], v[220:223]
    ds_read_b64_tr_b16 v[238:239], v246 offset:33792
    v_mfma_f32_16x16x32_bf16 v[224:227], v[14:17], v[80:83], v[224:227]
    ds_read_b64_tr_b16 v[240:241], v247 offset:32768
    ds_read_b64_tr_b16 v[242:243], v247 offset:33792
    s_waitcnt vmcnt(18) lgkmcnt(0)
    v_mfma_f32_16x16x32_bf16 v[196:199], v[228:231], v[84:87], v[196:199]
    s_mov_b32 s80, 16384
    buffer_load_dwordx4 v[164:167], v18, s[36:39], s80 offen offset:2048 sc1
    v_mfma_f32_16x16x32_bf16 v[200:203], v[228:231], v[88:91], v[200:203]
    buffer_load_dwordx4 v[168:171], v19, s[36:39], s80 offen offset:2048 sc1
    v_mfma_f32_16x16x32_bf16 v[204:207], v[232:235], v[84:87], v[204:207]
    ds_read_b64_tr_b16 v[2:3], v244 offset:36864
    v_mfma_f32_16x16x32_bf16 v[208:211], v[232:235], v[88:91], v[208:211]
    ds_read_b64_tr_b16 v[4:5], v244 offset:37888
    ds_read_b64_tr_b16 v[6:7], v245 offset:36864
    v_mfma_f32_16x16x32_bf16 v[212:215], v[236:239], v[84:87], v[212:215]
    ds_read_b64_tr_b16 v[8:9], v245 offset:37888
    v_mfma_f32_16x16x32_bf16 v[216:219], v[236:239], v[88:91], v[216:219]
    ds_read_b64_tr_b16 v[10:11], v246 offset:36864
    v_mfma_f32_16x16x32_bf16 v[220:223], v[240:243], v[84:87], v[220:223]
    ds_read_b64_tr_b16 v[12:13], v246 offset:37888
    v_mfma_f32_16x16x32_bf16 v[224:227], v[240:243], v[88:91], v[224:227]
    ds_read_b64_tr_b16 v[14:15], v247 offset:36864
    ds_read_b64_tr_b16 v[16:17], v247 offset:37888
    s_waitcnt vmcnt(18) lgkmcnt(0)
    v_mfma_f32_16x16x32_bf16 v[196:199], v[2:5], v[92:95], v[196:199]
    s_mov_b32 s80, 16384
    buffer_load_dwordx4 v[172:175], v18, s[36:39], s80 offen offset:3072 sc1
    v_mfma_f32_16x16x32_bf16 v[200:203], v[2:5], v[96:99], v[200:203]
    buffer_load_dwordx4 v[176:179], v19, s[36:39], s80 offen offset:3072 sc1
    v_mfma_f32_16x16x32_bf16 v[204:207], v[6:9], v[92:95], v[204:207]
    ds_read_b64_tr_b16 v[228:229], v244 offset:40960
    v_mfma_f32_16x16x32_bf16 v[208:211], v[6:9], v[96:99], v[208:211]
    ds_read_b64_tr_b16 v[230:231], v244 offset:41984
    ds_read_b64_tr_b16 v[232:233], v245 offset:40960
    v_mfma_f32_16x16x32_bf16 v[212:215], v[10:13], v[92:95], v[212:215]
    ds_read_b64_tr_b16 v[234:235], v245 offset:41984
    v_mfma_f32_16x16x32_bf16 v[216:219], v[10:13], v[96:99], v[216:219]
    ds_read_b64_tr_b16 v[236:237], v246 offset:40960
    v_mfma_f32_16x16x32_bf16 v[220:223], v[14:17], v[92:95], v[220:223]
    ds_read_b64_tr_b16 v[238:239], v246 offset:41984
    v_mfma_f32_16x16x32_bf16 v[224:227], v[14:17], v[96:99], v[224:227]
    ds_read_b64_tr_b16 v[240:241], v247 offset:40960
    ds_read_b64_tr_b16 v[242:243], v247 offset:41984
    s_waitcnt vmcnt(18) lgkmcnt(0)
    v_mfma_f32_16x16x32_bf16 v[196:199], v[228:231], v[100:103], v[196:199]
    s_mov_b32 s80, 20480
    buffer_load_dwordx4 v[180:183], v18, s[36:39], s80 offen offset:0 sc1
    v_mfma_f32_16x16x32_bf16 v[200:203], v[228:231], v[104:107], v[200:203]
    buffer_load_dwordx4 v[184:187], v19, s[36:39], s80 offen offset:0 sc1
    v_mfma_f32_16x16x32_bf16 v[204:207], v[232:235], v[100:103], v[204:207]
    ds_read_b64_tr_b16 v[2:3], v244 offset:45056
    v_mfma_f32_16x16x32_bf16 v[208:211], v[232:235], v[104:107], v[208:211]
    ds_read_b64_tr_b16 v[4:5], v244 offset:46080
    ds_read_b64_tr_b16 v[6:7], v245 offset:45056
    v_mfma_f32_16x16x32_bf16 v[212:215], v[236:239], v[100:103], v[212:215]
    ds_read_b64_tr_b16 v[8:9], v245 offset:46080
    v_mfma_f32_16x16x32_bf16 v[216:219], v[236:239], v[104:107], v[216:219]
    ds_read_b64_tr_b16 v[10:11], v246 offset:45056
    v_mfma_f32_16x16x32_bf16 v[220:223], v[240:243], v[100:103], v[220:223]
    ds_read_b64_tr_b16 v[12:13], v246 offset:46080
    v_mfma_f32_16x16x32_bf16 v[224:227], v[240:243], v[104:107], v[224:227]
    ds_read_b64_tr_b16 v[14:15], v247 offset:45056
    ds_read_b64_tr_b16 v[16:17], v247 offset:46080
    s_and_b32 s55, s50, 3
    s_lshl_b32 s55, s55, 4
    s_lshl_b32 s56, s48, 6
    s_add_u32 s55, s55, s56
    s_lshl_b32 s55, s55, 10
    s_lshl_b32 s56, s85, 7
    s_add_u32 s55, s55, s56
    s_lshr_b32 s56, s50, 2
    s_lshl_b32 s56, s56, 6
    s_add_u32 s55, s55, s56
    v_lshrrev_b32 v253, 2, v1
    v_lshlrev_b32 v253, 10, v253
    v_and_b32 v254, 3, v1
    v_lshl_add_u32 v253, v254, 4, v253
    v_add_u32 v96, s55, v253
    buffer_load_dwordx4 v[84:87], v96, s[8:11], 0 offen
    s_waitcnt vmcnt(19) lgkmcnt(0)
    v_mfma_f32_16x16x32_bf16 v[196:199], v[2:5], v[108:111], v[196:199]
    s_mov_b32 s80, 20480
    buffer_load_dwordx4 v[188:191], v18, s[36:39], s80 offen offset:1024 sc1
    v_mfma_f32_16x16x32_bf16 v[200:203], v[2:5], v[112:115], v[200:203]
    buffer_load_dwordx4 v[192:195], v19, s[36:39], s80 offen offset:1024 sc1
    v_mfma_f32_16x16x32_bf16 v[204:207], v[6:9], v[108:111], v[204:207]
    ds_read_b64_tr_b16 v[228:229], v244 offset:49152
    v_mfma_f32_16x16x32_bf16 v[208:211], v[6:9], v[112:115], v[208:211]
    ds_read_b64_tr_b16 v[230:231], v244 offset:50176
    ds_read_b64_tr_b16 v[232:233], v245 offset:49152
    v_mfma_f32_16x16x32_bf16 v[212:215], v[10:13], v[108:111], v[212:215]
    ds_read_b64_tr_b16 v[234:235], v245 offset:50176
    v_mfma_f32_16x16x32_bf16 v[216:219], v[10:13], v[112:115], v[216:219]
    ds_read_b64_tr_b16 v[236:237], v246 offset:49152
    v_mfma_f32_16x16x32_bf16 v[220:223], v[14:17], v[108:111], v[220:223]
    ds_read_b64_tr_b16 v[238:239], v246 offset:50176
    v_mfma_f32_16x16x32_bf16 v[224:227], v[14:17], v[112:115], v[224:227]
    ds_read_b64_tr_b16 v[240:241], v247 offset:49152
    ds_read_b64_tr_b16 v[242:243], v247 offset:50176
    s_waitcnt lgkmcnt(0)
    s_barrier
    s_waitcnt vmcnt(19)
    v_mfma_f32_16x16x32_bf16 v[196:199], v[228:231], v[116:119], v[196:199]
    v_add_u32 v244, s77, v244
    v_mfma_f32_16x16x32_bf16 v[200:203], v[228:231], v[120:123], v[200:203]
    v_add_u32 v245, s77, v245
    v_add_u32 v246, s77, v246
    v_mfma_f32_16x16x32_bf16 v[204:207], v[232:235], v[116:119], v[204:207]
    v_add_u32 v247, s77, v247
    v_mfma_f32_16x16x32_bf16 v[208:211], v[232:235], v[120:123], v[208:211]
    ds_read_b64_tr_b16 v[2:3], v244 offset:0
    ds_read_b64_tr_b16 v[4:5], v244 offset:1024
    v_mfma_f32_16x16x32_bf16 v[212:215], v[236:239], v[116:119], v[212:215]
    ds_read_b64_tr_b16 v[6:7], v245 offset:0
    v_mfma_f32_16x16x32_bf16 v[216:219], v[236:239], v[120:123], v[216:219]
    ds_read_b64_tr_b16 v[8:9], v245 offset:1024
    ds_read_b64_tr_b16 v[10:11], v246 offset:0
    v_mfma_f32_16x16x32_bf16 v[220:223], v[240:243], v[116:119], v[220:223]
    ds_read_b64_tr_b16 v[12:13], v246 offset:1024
    v_mfma_f32_16x16x32_bf16 v[224:227], v[240:243], v[120:123], v[224:227]
    ds_read_b64_tr_b16 v[14:15], v247 offset:0
    ds_read_b64_tr_b16 v[16:17], v247 offset:1024
    s_waitcnt vmcnt(17) lgkmcnt(0)
    v_mfma_f32_16x16x32_bf16 v[196:199], v[2:5], v[124:127], v[196:199]
    ds_read_b64_tr_b16 v[228:229], v244 offset:4096
    v_mfma_f32_16x16x32_bf16 v[200:203], v[2:5], v[128:131], v[200:203]
    ds_read_b64_tr_b16 v[230:231], v244 offset:5120
    v_mfma_f32_16x16x32_bf16 v[204:207], v[6:9], v[124:127], v[204:207]
    ds_read_b64_tr_b16 v[232:233], v245 offset:4096
    v_mfma_f32_16x16x32_bf16 v[208:211], v[6:9], v[128:131], v[208:211]
    ds_read_b64_tr_b16 v[234:235], v245 offset:5120
    v_mfma_f32_16x16x32_bf16 v[212:215], v[10:13], v[124:127], v[212:215]
    ds_read_b64_tr_b16 v[236:237], v246 offset:4096
    v_mfma_f32_16x16x32_bf16 v[216:219], v[10:13], v[128:131], v[216:219]
    ds_read_b64_tr_b16 v[238:239], v246 offset:5120
    v_mfma_f32_16x16x32_bf16 v[220:223], v[14:17], v[124:127], v[220:223]
    ds_read_b64_tr_b16 v[240:241], v247 offset:4096
    v_mfma_f32_16x16x32_bf16 v[224:227], v[14:17], v[128:131], v[224:227]
    ds_read_b64_tr_b16 v[242:243], v247 offset:5120
    s_waitcnt vmcnt(15) lgkmcnt(0)
    v_mfma_f32_16x16x32_bf16 v[196:199], v[228:231], v[132:135], v[196:199]
    ds_read_b64_tr_b16 v[2:3], v244 offset:8192
    v_mfma_f32_16x16x32_bf16 v[200:203], v[228:231], v[136:139], v[200:203]
    ds_read_b64_tr_b16 v[4:5], v244 offset:9216
    v_mfma_f32_16x16x32_bf16 v[204:207], v[232:235], v[132:135], v[204:207]
    ds_read_b64_tr_b16 v[6:7], v245 offset:8192
    v_mfma_f32_16x16x32_bf16 v[208:211], v[232:235], v[136:139], v[208:211]
    ds_read_b64_tr_b16 v[8:9], v245 offset:9216
    v_mfma_f32_16x16x32_bf16 v[212:215], v[236:239], v[132:135], v[212:215]
    ds_read_b64_tr_b16 v[10:11], v246 offset:8192
    v_mfma_f32_16x16x32_bf16 v[216:219], v[236:239], v[136:139], v[216:219]
    ds_read_b64_tr_b16 v[12:13], v246 offset:9216
    v_mfma_f32_16x16x32_bf16 v[220:223], v[240:243], v[132:135], v[220:223]
    ds_read_b64_tr_b16 v[14:15], v247 offset:8192
    v_mfma_f32_16x16x32_bf16 v[224:227], v[240:243], v[136:139], v[224:227]
    ds_read_b64_tr_b16 v[16:17], v247 offset:9216
    s_waitcnt vmcnt(13) lgkmcnt(0)
    v_mfma_f32_16x16x32_bf16 v[196:199], v[2:5], v[140:143], v[196:199]
    ds_read_b64_tr_b16 v[228:229], v244 offset:12288
    v_mfma_f32_16x16x32_bf16 v[200:203], v[2:5], v[144:147], v[200:203]
    ds_read_b64_tr_b16 v[230:231], v244 offset:13312
    v_mfma_f32_16x16x32_bf16 v[204:207], v[6:9], v[140:143], v[204:207]
    ds_read_b64_tr_b16 v[232:233], v245 offset:12288
    v_mfma_f32_16x16x32_bf16 v[208:211], v[6:9], v[144:147], v[208:211]
    ds_read_b64_tr_b16 v[234:235], v245 offset:13312
    v_mfma_f32_16x16x32_bf16 v[212:215], v[10:13], v[140:143], v[212:215]
    ds_read_b64_tr_b16 v[236:237], v246 offset:12288
    v_mfma_f32_16x16x32_bf16 v[216:219], v[10:13], v[144:147], v[216:219]
    ds_read_b64_tr_b16 v[238:239], v246 offset:13312
    v_mfma_f32_16x16x32_bf16 v[220:223], v[14:17], v[140:143], v[220:223]
    ds_read_b64_tr_b16 v[240:241], v247 offset:12288
    v_mfma_f32_16x16x32_bf16 v[224:227], v[14:17], v[144:147], v[224:227]
    ds_read_b64_tr_b16 v[242:243], v247 offset:13312
    s_waitcnt vmcnt(11) lgkmcnt(0)
    v_mfma_f32_16x16x32_bf16 v[196:199], v[228:231], v[148:151], v[196:199]
    ds_read_b64_tr_b16 v[2:3], v244 offset:16384
    v_mfma_f32_16x16x32_bf16 v[200:203], v[228:231], v[152:155], v[200:203]
    ds_read_b64_tr_b16 v[4:5], v244 offset:17408
    v_mfma_f32_16x16x32_bf16 v[204:207], v[232:235], v[148:151], v[204:207]
    ds_read_b64_tr_b16 v[6:7], v245 offset:16384
    v_mfma_f32_16x16x32_bf16 v[208:211], v[232:235], v[152:155], v[208:211]
    ds_read_b64_tr_b16 v[8:9], v245 offset:17408
    v_mfma_f32_16x16x32_bf16 v[212:215], v[236:239], v[148:151], v[212:215]
    ds_read_b64_tr_b16 v[10:11], v246 offset:16384
    v_mfma_f32_16x16x32_bf16 v[216:219], v[236:239], v[152:155], v[216:219]
    ds_read_b64_tr_b16 v[12:13], v246 offset:17408
    v_mfma_f32_16x16x32_bf16 v[220:223], v[240:243], v[148:151], v[220:223]
    ds_read_b64_tr_b16 v[14:15], v247 offset:16384
    v_mfma_f32_16x16x32_bf16 v[224:227], v[240:243], v[152:155], v[224:227]
    ds_read_b64_tr_b16 v[16:17], v247 offset:17408
    s_waitcnt vmcnt(9) lgkmcnt(0)
    v_mfma_f32_16x16x32_bf16 v[196:199], v[2:5], v[156:159], v[196:199]
    ds_read_b64_tr_b16 v[228:229], v244 offset:20480
    v_mfma_f32_16x16x32_bf16 v[200:203], v[2:5], v[160:163], v[200:203]
    ds_read_b64_tr_b16 v[230:231], v244 offset:21504
    v_mfma_f32_16x16x32_bf16 v[204:207], v[6:9], v[156:159], v[204:207]
    ds_read_b64_tr_b16 v[232:233], v245 offset:20480
    v_mfma_f32_16x16x32_bf16 v[208:211], v[6:9], v[160:163], v[208:211]
    ds_read_b64_tr_b16 v[234:235], v245 offset:21504
    v_mfma_f32_16x16x32_bf16 v[212:215], v[10:13], v[156:159], v[212:215]
    ds_read_b64_tr_b16 v[236:237], v246 offset:20480
    v_mfma_f32_16x16x32_bf16 v[216:219], v[10:13], v[160:163], v[216:219]
    ds_read_b64_tr_b16 v[238:239], v246 offset:21504
    v_mfma_f32_16x16x32_bf16 v[220:223], v[14:17], v[156:159], v[220:223]
    ds_read_b64_tr_b16 v[240:241], v247 offset:20480
    v_mfma_f32_16x16x32_bf16 v[224:227], v[14:17], v[160:163], v[224:227]
    ds_read_b64_tr_b16 v[242:243], v247 offset:21504
    s_waitcnt lgkmcnt(0)
    s_barrier
    s_waitcnt vmcnt(7)
    v_mfma_f32_16x16x32_bf16 v[196:199], v[228:231], v[164:167], v[196:199]
    v_add_u32 v244, s79, v244
    v_mfma_f32_16x16x32_bf16 v[200:203], v[228:231], v[168:171], v[200:203]
    v_add_u32 v245, s79, v245
    v_add_u32 v246, s79, v246
    v_mfma_f32_16x16x32_bf16 v[204:207], v[232:235], v[164:167], v[204:207]
    v_add_u32 v247, s79, v247
    v_mfma_f32_16x16x32_bf16 v[208:211], v[232:235], v[168:171], v[208:211]
    ds_read_b64_tr_b16 v[2:3], v244 offset:0
    ds_read_b64_tr_b16 v[4:5], v244 offset:1024
    v_mfma_f32_16x16x32_bf16 v[212:215], v[236:239], v[164:167], v[212:215]
    ds_read_b64_tr_b16 v[6:7], v245 offset:0
    v_mfma_f32_16x16x32_bf16 v[216:219], v[236:239], v[168:171], v[216:219]
    ds_read_b64_tr_b16 v[8:9], v245 offset:1024
    ds_read_b64_tr_b16 v[10:11], v246 offset:0
    v_mfma_f32_16x16x32_bf16 v[220:223], v[240:243], v[164:167], v[220:223]
    ds_read_b64_tr_b16 v[12:13], v246 offset:1024
    v_mfma_f32_16x16x32_bf16 v[224:227], v[240:243], v[168:171], v[224:227]
    ds_read_b64_tr_b16 v[14:15], v247 offset:0
    ds_read_b64_tr_b16 v[16:17], v247 offset:1024
    s_waitcnt vmcnt(5) lgkmcnt(0)
    v_mfma_f32_16x16x32_bf16 v[196:199], v[2:5], v[172:175], v[196:199]
    ds_read_b64_tr_b16 v[228:229], v244 offset:4096
    v_mfma_f32_16x16x32_bf16 v[200:203], v[2:5], v[176:179], v[200:203]
    ds_read_b64_tr_b16 v[230:231], v244 offset:5120
    v_mfma_f32_16x16x32_bf16 v[204:207], v[6:9], v[172:175], v[204:207]
    ds_read_b64_tr_b16 v[232:233], v245 offset:4096
    v_mfma_f32_16x16x32_bf16 v[208:211], v[6:9], v[176:179], v[208:211]
    ds_read_b64_tr_b16 v[234:235], v245 offset:5120
    v_mfma_f32_16x16x32_bf16 v[212:215], v[10:13], v[172:175], v[212:215]
    ds_read_b64_tr_b16 v[236:237], v246 offset:4096
    v_mfma_f32_16x16x32_bf16 v[216:219], v[10:13], v[176:179], v[216:219]
    ds_read_b64_tr_b16 v[238:239], v246 offset:5120
    v_mfma_f32_16x16x32_bf16 v[220:223], v[14:17], v[172:175], v[220:223]
    ds_read_b64_tr_b16 v[240:241], v247 offset:4096
    v_mfma_f32_16x16x32_bf16 v[224:227], v[14:17], v[176:179], v[224:227]
    ds_read_b64_tr_b16 v[242:243], v247 offset:5120
    s_waitcnt vmcnt(3) lgkmcnt(0)
    v_mfma_f32_16x16x32_bf16 v[196:199], v[228:231], v[180:183], v[196:199]
    ds_read_b64_tr_b16 v[2:3], v244 offset:8192
    v_mfma_f32_16x16x32_bf16 v[200:203], v[228:231], v[184:187], v[200:203]
    ds_read_b64_tr_b16 v[4:5], v244 offset:9216
    v_mfma_f32_16x16x32_bf16 v[204:207], v[232:235], v[180:183], v[204:207]
    ds_read_b64_tr_b16 v[6:7], v245 offset:8192
    v_mfma_f32_16x16x32_bf16 v[208:211], v[232:235], v[184:187], v[208:211]
    ds_read_b64_tr_b16 v[8:9], v245 offset:9216
    v_mfma_f32_16x16x32_bf16 v[212:215], v[236:239], v[180:183], v[212:215]
    ds_read_b64_tr_b16 v[10:11], v246 offset:8192
    v_mfma_f32_16x16x32_bf16 v[216:219], v[236:239], v[184:187], v[216:219]
    ds_read_b64_tr_b16 v[12:13], v246 offset:9216
    v_mfma_f32_16x16x32_bf16 v[220:223], v[240:243], v[180:183], v[220:223]
    ds_read_b64_tr_b16 v[14:15], v247 offset:8192
    v_mfma_f32_16x16x32_bf16 v[224:227], v[240:243], v[184:187], v[224:227]
    ds_read_b64_tr_b16 v[16:17], v247 offset:9216
    s_cmp_eq_u32 s75, 1
    s_cbranch_scc1 L_g2l_27
    s_waitcnt vmcnt(0) lgkmcnt(0)
    v_mfma_f32_16x16x32_bf16 v[196:199], v[2:5], v[188:191], v[196:199]
    v_mfma_f32_16x16x32_bf16 v[200:203], v[2:5], v[192:195], v[200:203]
    v_mfma_f32_16x16x32_bf16 v[204:207], v[6:9], v[188:191], v[204:207]
    v_mfma_f32_16x16x32_bf16 v[208:211], v[6:9], v[192:195], v[208:211]
    v_mfma_f32_16x16x32_bf16 v[212:215], v[10:13], v[188:191], v[212:215]
    v_mfma_f32_16x16x32_bf16 v[216:219], v[10:13], v[192:195], v[216:219]
    v_mfma_f32_16x16x32_bf16 v[220:223], v[14:17], v[188:191], v[220:223]
    v_mfma_f32_16x16x32_bf16 v[224:227], v[14:17], v[192:195], v[224:227]
L_g2l_27:
    s_waitcnt lgkmcnt(0)
    v_and_b32 v2, 15, v1
    v_lshrrev_b32 v3, 4, v1
    v_mul_u32_u24 v2, 272, v2
    v_lshl_add_u32 v2, v3, 4, v2
    s_mul_i32 s4, s75, 53248
    s_mul_i32 s5, s76, 8704
    s_add_u32 s4, s4, s5
    s_add_u32 s4, s4, 28672
    v_add_u32 v2, s4, v2
    ds_write_b128 v2, v[196:199] offset:0
    ds_write_b128 v2, v[200:203] offset:4352
    ds_write_b128 v2, v[204:207] offset:64
    ds_write_b128 v2, v[208:211] offset:4416
    ds_write_b128 v2, v[212:215] offset:128
    ds_write_b128 v2, v[216:219] offset:4480
    ds_write_b128 v2, v[220:223] offset:192
    ds_write_b128 v2, v[224:227] offset:4544
    s_waitcnt lgkmcnt(0)
    s_barrier
L_final:
    s_and_b32 s55, s50, 3
    s_lshr_b32 s56, s50, 2
    v_lshrrev_b32 v2, 2, v1
    v_and_b32 v3, 3, v1
    s_lshl_b32 s4, s55, 4
    v_add_u32 v2, s4, v2
    v_mul_u32_u24 v4, 272, v2
    v_lshl_add_u32 v4, v3, 5, v4
    s_lshl_b32 s4, s56, 7
    s_add_u32 s4, s4, 28672
    v_add_u32 v4, s4, v4
    ds_read_b128 v[20:23], v4
    ds_read_b128 v[24:27], v4 offset:16
    ds_read_b128 v[28:31], v4 offset:53248
    ds_read_b128 v[32:35], v4 offset:53264
    v_lshlrev_b32 v6, 3, v2
    v_add_u32 v6, 161792, v6
    ds_read_b64 v[36:37], v6
    v_lshrrev_b32 v7, 4, v1
    v_lshlrev_b32 v7, 3, v7
    v_and_b32 v8, 15, v1
    v_lshrrev_b32 v8, 2, v8
    v_add_u32 v7, v7, v8
    s_lshl_b32 s4, s56, 5
    v_add_u32 v7, s4, v7
    v_mul_u32_u24 v7, 144, v7
    v_and_b32 v8, 3, v1
    v_lshl_add_u32 v7, v8, 3, v7
    s_lshl_b32 s4, s55, 5
    s_add_u32 s4, s4, 16384
    v_add_u32 v7, s4, v7
    ds_read_b64_tr_b16 v[38:39], v7
    ds_read_b64_tr_b16 v[40:41], v7 offset:576
    v_and_b32 v8, 3, v1
    v_lshlrev_b32 v8, 4, v8
    v_lshrrev_b32 v9, 2, v1
    v_or_b32 v8, v8, v9
    v_lshlrev_b32 v8, 2, v8
    v_mov_b32 v10, 0xbfb8aa3b
    v_mov_b32 v11, 1.0
    s_waitcnt lgkmcnt(0)
    ds_bpermute_b32 v42, v8, v38
    ds_bpermute_b32 v43, v8, v39
    ds_bpermute_b32 v44, v8, v40
    ds_bpermute_b32 v45, v8, v41
    v_add_f32 v20, v20, v28
    v_add_f32 v21, v21, v29
    v_add_f32 v22, v22, v30
    v_add_f32 v23, v23, v31
    v_add_f32 v24, v24, v32
    v_add_f32 v25, v25, v33
    v_add_f32 v26, v26, v34
    v_add_f32 v27, v27, v35
    v_cvt_pk_bf16_f32 v28, v20, v21
    v_cvt_pk_bf16_f32 v29, v22, v23
    v_cvt_pk_bf16_f32 v30, v24, v25
    v_cvt_pk_bf16_f32 v31, v26, v27
    v_alignbit_b32 v20, v28, 0, 16
    v_and_b32 v21, v249, v28
    v_alignbit_b32 v22, v29, 0, 16
    v_and_b32 v23, v249, v29
    v_alignbit_b32 v24, v30, 0, 16
    v_and_b32 v25, v249, v30
    v_alignbit_b32 v26, v31, 0, 16
    v_and_b32 v27, v249, v31
    v_mul_f32 v48, v10, v20
    v_mul_f32 v49, v10, v21
    v_mul_f32 v50, v10, v22
    v_mul_f32 v51, v10, v23
    v_mul_f32 v52, v10, v24
    v_mul_f32 v53, v10, v25
    v_mul_f32 v54, v10, v26
    v_mul_f32 v55, v10, v27
    v_exp_f32 v48, v48
    v_exp_f32 v49, v49
    v_exp_f32 v50, v50
    v_exp_f32 v51, v51
    v_exp_f32 v52, v52
    v_exp_f32 v53, v53
    v_exp_f32 v54, v54
    v_exp_f32 v55, v55
    s_waitcnt vmcnt(0)
    v_sub_f32 v12, 0, v36
    v_dot2_f32_bf16 v72, v84, v250, v12
    v_dot2_f32_bf16 v73, v84, v251, v12
    v_dot2_f32_bf16 v74, v85, v250, v12
    v_dot2_f32_bf16 v75, v85, v251, v12
    v_dot2_f32_bf16 v76, v86, v250, v12
    v_dot2_f32_bf16 v77, v86, v251, v12
    v_dot2_f32_bf16 v78, v87, v250, v12
    v_dot2_f32_bf16 v79, v87, v251, v12
    v_add_f32 v48, v11, v48
    v_add_f32 v49, v11, v49
    v_add_f32 v50, v11, v50
    v_add_f32 v51, v11, v51
    v_add_f32 v52, v11, v52
    v_add_f32 v53, v11, v53
    v_add_f32 v54, v11, v54
    v_add_f32 v55, v11, v55
    v_cvt_pk_bf16_f32 v80, v72, v73
    v_cvt_pk_bf16_f32 v81, v74, v75
    v_cvt_pk_bf16_f32 v82, v76, v77
    v_cvt_pk_bf16_f32 v83, v78, v79
    v_rcp_f32 v48, v48
    v_rcp_f32 v49, v49
    v_rcp_f32 v50, v50
    v_rcp_f32 v51, v51
    v_rcp_f32 v52, v52
    v_rcp_f32 v53, v53
    v_rcp_f32 v54, v54
    v_rcp_f32 v55, v55
    v_alignbit_b32 v72, v80, 0, 16
    v_and_b32 v73, v249, v80
    v_alignbit_b32 v74, v81, 0, 16
    v_and_b32 v75, v249, v81
    v_alignbit_b32 v76, v82, 0, 16
    v_and_b32 v77, v249, v82
    v_alignbit_b32 v78, v83, 0, 16
    v_and_b32 v79, v249, v83
    v_mul_f32 v72, v72, v37
    v_mul_f32 v73, v73, v37
    v_mul_f32 v74, v74, v37
    v_mul_f32 v75, v75, v37
    v_mul_f32 v76, v76, v37
    v_mul_f32 v77, v77, v37
    v_mul_f32 v78, v78, v37
    v_mul_f32 v79, v79, v37
    v_mul_f32 v20, v20, v48
    v_mul_f32 v21, v21, v49
    v_mul_f32 v22, v22, v50
    v_mul_f32 v23, v23, v51
    v_mul_f32 v24, v24, v52
    v_mul_f32 v25, v25, v53
    v_mul_f32 v26, v26, v54
    v_mul_f32 v27, v27, v55
    v_cvt_pk_bf16_f32 v80, v72, v73
    v_cvt_pk_bf16_f32 v81, v74, v75
    v_cvt_pk_bf16_f32 v82, v76, v77
    v_cvt_pk_bf16_f32 v83, v78, v79
    v_cvt_pk_bf16_f32 v28, v20, v21
    v_cvt_pk_bf16_f32 v29, v22, v23
    v_cvt_pk_bf16_f32 v30, v24, v25
    v_cvt_pk_bf16_f32 v31, v26, v27
    s_waitcnt lgkmcnt(0)
    v_and_b32 v56, v248, v42
    v_and_b32 v57, v249, v42
    v_and_b32 v64, v248, v28
    v_and_b32 v65, v249, v28
    v_and_b32 v58, v248, v43
    v_and_b32 v59, v249, v43
    v_and_b32 v66, v248, v29
    v_and_b32 v67, v249, v29
    v_and_b32 v60, v248, v44
    v_and_b32 v61, v249, v44
    v_and_b32 v68, v248, v30
    v_and_b32 v69, v249, v30
    v_and_b32 v62, v248, v45
    v_and_b32 v63, v249, v45
    v_and_b32 v70, v248, v31
    v_and_b32 v71, v249, v31
    v_dot2_f32_bf16 v72, v80, v56, 0
    v_dot2_f32_bf16 v73, v80, v57, 0
    v_dot2_f32_bf16 v74, v81, v58, 0
    v_dot2_f32_bf16 v75, v81, v59, 0
    v_dot2_f32_bf16 v76, v82, v60, 0
    v_dot2_f32_bf16 v77, v82, v61, 0
    v_dot2_f32_bf16 v78, v83, v62, 0
    v_dot2_f32_bf16 v79, v83, v63, 0
    v_alignbit_b32 v88, v84, 0, 16
    v_and_b32 v89, v249, v84
    v_alignbit_b32 v90, v85, 0, 16
    v_and_b32 v91, v249, v85
    v_alignbit_b32 v92, v86, 0, 16
    v_and_b32 v93, v249, v86
    v_alignbit_b32 v94, v87, 0, 16
    v_and_b32 v95, v249, v87
    v_cvt_pk_bf16_f32 v80, v72, v73
    v_cvt_pk_bf16_f32 v81, v74, v75
    v_cvt_pk_bf16_f32 v82, v76, v77
    v_cvt_pk_bf16_f32 v83, v78, v79
    v_dot2_f32_bf16 v72, v80, v64, 0
    v_dot2_f32_bf16 v73, v80, v65, 0
    v_dot2_f32_bf16 v74, v81, v66, 0
    v_dot2_f32_bf16 v75, v81, v67, 0
    v_dot2_f32_bf16 v76, v82, v68, 0
    v_dot2_f32_bf16 v77, v82, v69, 0
    v_dot2_f32_bf16 v78, v83, v70, 0
    v_dot2_f32_bf16 v79, v83, v71, 0
    v_cvt_pk_bf16_f32 v80, v72, v73
    v_cvt_pk_bf16_f32 v81, v74, v75
    v_cvt_pk_bf16_f32 v82, v76, v77
    v_cvt_pk_bf16_f32 v83, v78, v79
    v_dot2_f32_bf16 v72, v80, v250, v88
    v_dot2_f32_bf16 v73, v80, v251, v89
    v_dot2_f32_bf16 v74, v81, v250, v90
    v_dot2_f32_bf16 v75, v81, v251, v91
    v_dot2_f32_bf16 v76, v82, v250, v92
    v_dot2_f32_bf16 v77, v82, v251, v93
    v_dot2_f32_bf16 v78, v83, v250, v94
    v_dot2_f32_bf16 v79, v83, v251, v95
    v_cvt_pk_bf16_f32 v80, v72, v73
    v_cvt_pk_bf16_f32 v81, v74, v75
    v_cvt_pk_bf16_f32 v82, v76, v77
    v_cvt_pk_bf16_f32 v83, v78, v79
    buffer_store_dwordx4 v[80:83], v96, s[28:31], 0 offen sc1
L_end:
    s_endpgm
L_codeend:
    s_endpgm
.section .rodata,"a"
.p2align 6
.amdhsa_kernel recurrent_scan__ssm_conv_h3__dense_activation_relu__prompt_kernel
  .amdhsa_next_free_vgpr 256
  .amdhsa_next_free_sgpr 102
  .amdhsa_accum_offset 256
  .amdhsa_group_segment_fixed_size 0
  .amdhsa_kernarg_size 96
  .amdhsa_user_sgpr_count 2
  .amdhsa_user_sgpr_kernarg_segment_ptr 1
  .amdhsa_system_sgpr_workgroup_id_x 1
.end_amdhsa_kernel
```
